```python
import torch

def _softmax(x, axis=-1):
    return torch.softmax(x, dim=axis)
def _gelu(x):
    return torch.nn.functional.gelu(x, approximate="tanh")
def _silu(x):
    return torch.nn.functional.silu(x)
def _sigmoid(x):
    return torch.sigmoid(x)
def _layernorm(x, axis=-1, eps=1e-5):
    m = x.mean(dim=axis, keepdim=True)
    v = x.var(dim=axis, keepdim=True, unbiased=False)
    return (x - m) / torch.sqrt(v + eps)
def _scatter_add(tgt, idx, src, axis=0):
    return tgt.clone().index_add_(axis, idx, src)
def _segment_sum(src, seg, n):
    out = torch.zeros((n,) + src.shape[1:], dtype=src.dtype)
    return out.index_add_(0, seg, src)
def _pad(x, pw):
    flat = tuple(v for pair in reversed(pw) for v in pair)
    return torch.nn.functional.pad(x, flat)

kernel_name = 'parallel_sum__gqa_block_cached__mixer_channel_mlp__decode'

def setup_inputs():

    _w = (lambda a: (lambda t: t.to(torch.bfloat16) if t.is_floating_point() else t)(torch.as_tensor(a)))
    def _A_setup():
        B, Sq, D = 1, 1, 640
        Hq, Hkv, Sk, Dh = 32, 32, 16384, 128
        assert Hq % Hkv == 0, (Hq, Hkv)
        return {
            "x": _w((lambda *s: torch.randn(*s, dtype=torch.bfloat16) * 0.05)(B, Sq, D)),
            "k_cache": _w((lambda *s: torch.randn(*s, dtype=torch.bfloat16) * 3.2)(B, Hkv, Sk, Dh)),
            "v_cache": _w((lambda *s: torch.randn(*s, dtype=torch.bfloat16) * 0.4)(B, Hkv, Sk, Dh)),
            "wq": _w((lambda *s: torch.randn(*s, dtype=torch.bfloat16) * 3.2)(D, Hq * Dh) * (D ** -0.5)),
            "wo": _w((lambda *s: torch.randn(*s, dtype=torch.bfloat16) * 0.4)(Hq * Dh, D) * ((Hq * Dh) ** -0.5)),
        }
    _A_in = _A_setup()

    def _B_setup():
        B, S, D, F = 1, 1, 640, 1728
        return {
            "x": _w((lambda *s: torch.randn(*s, dtype=torch.bfloat16) * 0.05)(B, S, D)),
            "w1": _w((lambda *s: torch.randn(*s, dtype=torch.bfloat16) * 3.2)(D, F) * (D ** -0.5)),
            "b1": _w((lambda *s: torch.randn(*s, dtype=torch.bfloat16) * 0.8)(F)),
            "w2": _w((lambda *s: torch.randn(*s, dtype=torch.bfloat16) * 0.1)(F, D) * (F ** -0.5)),
            "b2": _w((lambda *s: torch.randn(*s, dtype=torch.bfloat16) * 0.1)(D)),
        }
    _B_in = _B_setup()

    return {
        "A_x": _A_in["x"],
        "A_k_cache": _A_in["k_cache"],
        "A_v_cache": _A_in["v_cache"],
        "A_wq": _A_in["wq"],
        "A_wo": _A_in["wo"],
        "B_x": _B_in["x"],
        "B_w1": _B_in["w1"],
        "B_b1": _B_in["b1"],
        "B_w2": _B_in["w2"],
        "B_b2": _B_in["b2"],
    }

def reference(A_x, A_k_cache, A_v_cache, A_wq, A_wo, B_x, B_w1, B_b1, B_w2, B_b2):
    def _A_ref(x, k_cache, v_cache, wq, wo):
        B, Sq, D = x.shape
        Hq, Dh = 32, 128
        Hkv = k_cache.shape[1]
        rep = Hq // Hkv
        q = (lambda x, *d: x.permute(*d))((x @ wq).reshape(B, Sq, Hq, Dh), 0, 2, 1, 3)
        k = (lambda x, n, axis: torch.repeat_interleave(x, n, dim=axis))(k_cache, rep, axis=1)
        v = (lambda x, n, axis: torch.repeat_interleave(x, n, dim=axis))(v_cache, rep, axis=1)
        scores = torch.einsum("bhqd,bhkd->bhqk", q, k) * (Dh ** -0.5)
        p = _softmax(scores, axis=-1)
        o = torch.einsum("bhqk,bhkd->bhqd", p, v)
        return (lambda x, *d: x.permute(*d))(o, 0, 2, 1, 3).reshape(B, Sq, Hq * Dh) @ wo

    def _B_ref(x, w1, b1, w2, b2):
        y = _layernorm(x, axis=-1)
        h = _gelu(torch.einsum("bsd,df->bsf", y, w1) + b1)
        return torch.einsum("bsf,fd->bsd", h, w2) + b2

    x = A_x
    xn = _layernorm(x, axis=-1)
    return x + _A_ref(xn, A_k_cache, A_v_cache, A_wq, A_wo) + _B_ref(xn, B_w1, B_b1, B_w2, B_b2)
```

```asm
; @launch grid=(256,1,1) block=(512,1,1) lds=10240
.amdgcn_target "amdgcn-amd-amdhsa--gfx950"
.text
.globl parallel_sum__gqa_block_cached__mixer_channel_mlp__decode_kernel
.p2align 8
.type parallel_sum__gqa_block_cached__mixer_channel_mlp__decode_kernel,@function
parallel_sum__gqa_block_cached__mixer_channel_mlp__decode_kernel:
  s_cmp_ge_u32 s2, 256
  s_cbranch_scc1 L_END
  s_bfe_u32 s32, s2, 0x10000
  s_bfe_u32 s33, s2, 0x10002
  s_lshl_b32 s33, s33, 1
  s_or_b32 s32, s32, s33
  s_bfe_u32 s33, s2, 0x10007
  s_lshl_b32 s33, s33, 2
  s_or_b32 s32, s32, s33
  s_bfe_u32 s33, s2, 0x40003
  s_lshl_b32 s33, s33, 3
  s_or_b32 s32, s32, s33
  s_bfe_u32 s33, s2, 0x10001
  s_lshl_b32 s33, s33, 7
  s_or_b32 s32, s32, s33
  s_mov_b32 s2, s32
  s_lshr_b32 s33, s2, 3
  s_and_b32 s33, s33, 7
  s_xor_b32 s2, s2, s33
  s_load_dwordx16 s[4:19], s[0:1], 0
  s_load_dwordx8 s[20:27], s[0:1], 64
  s_load_dwordx2 s[28:29], s[0:1], 96
  v_lshrrev_b32 v1, 6, v0
  v_and_b32 v0, 63, v0
  v_readfirstlane_b32 s3, v1
  s_lshr_b32 s32, s2, 3
  s_and_b32 s33, s2, 7
  v_lshrrev_b32 v4, 4, v0
  v_and_b32 v5, 15, v0
  s_waitcnt lgkmcnt(0)
  s_mov_b32 s36, s28
  s_mov_b32 s37, s29
  s_mov_b32 s38, 4194304
  s_mov_b32 s39, 0x20000
  s_cmp_ge_u32 s3, 4
  s_cbranch_scc1 L_STREAM
  s_load_dwordx2 s[30:31], s[28:29], 0
  s_mov_b32 s80, 0
  s_cmp_eq_u32 s3, 1
  s_cbranch_scc1 L_H1
  s_cmp_eq_u32 s3, 2
  s_cbranch_scc1 L_H2
  s_cmp_eq_u32 s3, 3
  s_cbranch_scc1 L_FIN
  s_mov_b32 s40, s4
  s_mov_b32 s41, s5
  s_mov_b32 s42, 1280
  s_mov_b32 s43, 0x20000
  s_mov_b32 s44, s10
  s_mov_b32 s45, s11
  s_mov_b32 s46, 5242880
  s_mov_b32 s47, 0x20000
  v_lshlrev_b32 v2, 2, v0
  buffer_load_dword v10, v2, s[40:43], 0 offen offset:0
  buffer_load_dword v11, v2, s[40:43], 0 offen offset:256
  buffer_load_dword v12, v2, s[40:43], 0 offen offset:512
  buffer_load_dword v13, v2, s[40:43], 0 offen offset:768
  buffer_load_dword v14, v2, s[40:43], 0 offen offset:1024
  v_lshrrev_b32 v6, 3, v0
  v_and_b32 v7, 7, v0
  v_mul_u32_u24 v3, 163840, v6
  v_lshl_add_u32 v3, v7, 4, v3
  s_lshr_b32 s58, s33, 1
  s_and_b32 s59, s33, 1
  s_mul_i32 s56, s58, 1310720
  s_lshl_b32 s57, s32, 8
  s_add_u32 s56, s56, s57
  s_lshl_b32 s57, s59, 7
  s_add_u32 s56, s56, s57
  buffer_load_dwordx4 v[100:103], v3, s[44:47], s56 offen nt
  s_add_u32 s56, s56, 8192
  buffer_load_dwordx4 v[104:107], v3, s[44:47], s56 offen nt
  s_add_u32 s56, s56, 8192
  buffer_load_dwordx4 v[108:111], v3, s[44:47], s56 offen nt
  s_add_u32 s56, s56, 8192
  buffer_load_dwordx4 v[112:115], v3, s[44:47], s56 offen nt
  s_add_u32 s56, s56, 8192
  buffer_load_dwordx4 v[116:119], v3, s[44:47], s56 offen nt
  s_add_u32 s56, s56, 8192
  buffer_load_dwordx4 v[120:123], v3, s[44:47], s56 offen nt
  s_add_u32 s56, s56, 8192
  buffer_load_dwordx4 v[124:127], v3, s[44:47], s56 offen nt
  s_add_u32 s56, s56, 8192
  buffer_load_dwordx4 v[128:131], v3, s[44:47], s56 offen nt
  s_add_u32 s56, s56, 8192
  buffer_load_dwordx4 v[132:135], v3, s[44:47], s56 offen nt
  s_add_u32 s56, s56, 8192
  buffer_load_dwordx4 v[136:139], v3, s[44:47], s56 offen nt
  s_add_u32 s56, s56, 8192
  buffer_load_dwordx4 v[140:143], v3, s[44:47], s56 offen nt
  s_add_u32 s56, s56, 8192
  buffer_load_dwordx4 v[144:147], v3, s[44:47], s56 offen nt
  s_add_u32 s56, s56, 8192
  buffer_load_dwordx4 v[148:151], v3, s[44:47], s56 offen nt
  s_add_u32 s56, s56, 8192
  buffer_load_dwordx4 v[152:155], v3, s[44:47], s56 offen nt
  s_add_u32 s56, s56, 8192
  buffer_load_dwordx4 v[156:159], v3, s[44:47], s56 offen nt
  s_add_u32 s56, s56, 8192
  buffer_load_dwordx4 v[160:163], v3, s[44:47], s56 offen nt
  s_add_u32 s56, s56, 8192
  buffer_load_dwordx4 v[164:167], v3, s[44:47], s56 offen nt
  s_add_u32 s56, s56, 8192
  buffer_load_dwordx4 v[168:171], v3, s[44:47], s56 offen nt
  s_add_u32 s56, s56, 8192
  buffer_load_dwordx4 v[172:175], v3, s[44:47], s56 offen nt
  s_add_u32 s56, s56, 8192
  buffer_load_dwordx4 v[176:179], v3, s[44:47], s56 offen nt
  s_mul_i32 s70, s32, 256
  s_add_u32 s70, s70, 1114112
  s_cmp_eq_u32 s33, 0
  s_cselect_b32 s57, s70, 1073741824
  v_mov_b32 v8, 0
  s_mov_b64 exec, 1
  buffer_store_dword v8, v8, s[36:39], s57 offen sc1
  s_mov_b64 exec, -1
  s_barrier
  v_and_b32 v26, 1, v0
  v_cmp_eq_u32 vcc, 1, v26
  v_mov_b32 v26, 0x0000ffff
  v_mov_b32 v27, 0xffff0000
  v_cndmask_b32 v26, v26, v27, vcc
  v_and_b32 v27, 7, v0
  v_lshrrev_b32 v27, 1, v27
  v_cmp_eq_u32 vcc, 0, v27
  s_nop 1
  v_cndmask_b32 v32, 0, v26, vcc
  v_cmp_eq_u32 vcc, 1, v27
  s_nop 1
  v_cndmask_b32 v33, 0, v26, vcc
  v_cmp_eq_u32 vcc, 2, v27
  s_nop 1
  v_cndmask_b32 v34, 0, v26, vcc
  v_cmp_eq_u32 vcc, 3, v27
  s_nop 1
  v_cndmask_b32 v35, 0, v26, vcc
  v_mul_u32_u24 v7, 80, v6
  v_lshlrev_b32 v6, 3, v0
  s_mul_i32 s57, s58, 640
  v_add_u32 v7, s57, v7
  s_waitcnt vmcnt(21)
  v_lshlrev_b32 v16, 16, v10
  v_and_b32 v17, 0xffff0000, v10
  v_lshlrev_b32 v18, 16, v11
  v_and_b32 v19, 0xffff0000, v11
  v_lshlrev_b32 v20, 16, v12
  v_and_b32 v21, 0xffff0000, v12
  v_lshlrev_b32 v22, 16, v13
  v_and_b32 v23, 0xffff0000, v13
  v_lshlrev_b32 v24, 16, v14
  v_and_b32 v25, 0xffff0000, v14
  v_add_f32 v26, v16, v17
  v_add_f32 v26, v26, v18
  v_add_f32 v26, v26, v19
  v_add_f32 v26, v26, v20
  v_add_f32 v26, v26, v21
  v_add_f32 v26, v26, v22
  v_add_f32 v26, v26, v23
  v_add_f32 v26, v26, v24
  v_add_f32 v26, v26, v25
  s_nop 1
  v_add_f32_dpp v26, v26, v26 row_ror:8 row_mask:0xf bank_mask:0xf
  s_nop 1
  v_add_f32_dpp v26, v26, v26 row_ror:4 row_mask:0xf bank_mask:0xf
  s_nop 1
  v_add_f32_dpp v26, v26, v26 row_ror:2 row_mask:0xf bank_mask:0xf
  s_nop 1
  v_add_f32_dpp v26, v26, v26 row_ror:1 row_mask:0xf bank_mask:0xf
  v_mov_b32 v27, v26
  s_nop 1
  v_permlane16_swap_b32 v26, v27
  v_add_f32 v26, v26, v27
  v_mov_b32 v27, v26
  s_nop 1
  v_permlane32_swap_b32 v26, v27
  v_add_f32 v26, v26, v27
  v_mul_f32 v26, 0x3acccccd, v26
  v_sub_f32 v28, v16, v26
  v_mul_f32 v29, v28, v28
  v_sub_f32 v28, v17, v26
  v_fmac_f32 v29, v28, v28
  v_sub_f32 v28, v18, v26
  v_fmac_f32 v29, v28, v28
  v_sub_f32 v28, v19, v26
  v_fmac_f32 v29, v28, v28
  v_sub_f32 v28, v20, v26
  v_fmac_f32 v29, v28, v28
  v_sub_f32 v28, v21, v26
  v_fmac_f32 v29, v28, v28
  v_sub_f32 v28, v22, v26
  v_fmac_f32 v29, v28, v28
  v_sub_f32 v28, v23, v26
  v_fmac_f32 v29, v28, v28
  v_sub_f32 v28, v24, v26
  v_fmac_f32 v29, v28, v28
  v_sub_f32 v28, v25, v26
  v_fmac_f32 v29, v28, v28
  s_nop 1
  v_add_f32_dpp v29, v29, v29 row_ror:8 row_mask:0xf bank_mask:0xf
  s_nop 1
  v_add_f32_dpp v29, v29, v29 row_ror:4 row_mask:0xf bank_mask:0xf
  s_nop 1
  v_add_f32_dpp v29, v29, v29 row_ror:2 row_mask:0xf bank_mask:0xf
  s_nop 1
  v_add_f32_dpp v29, v29, v29 row_ror:1 row_mask:0xf bank_mask:0xf
  v_mov_b32 v27, v29
  s_nop 1
  v_permlane16_swap_b32 v29, v27
  v_add_f32 v29, v29, v27
  v_mov_b32 v27, v29
  s_nop 1
  v_permlane32_swap_b32 v29, v27
  v_add_f32 v29, v29, v27
  v_mul_f32 v29, 0x3acccccd, v29
  v_cvt_pk_bf16_f32 v29, v29, v29
  v_and_b32 v29, 0xffff0000, v29
  v_add_f32 v29, 0x3727c5ac, v29
  v_cvt_pk_bf16_f32 v29, v29, v29
  v_and_b32 v29, 0xffff0000, v29
  v_sqrt_f32 v29, v29
  v_cvt_pk_bf16_f32 v26, v26, v26
  v_and_b32 v26, 0xffff0000, v26
  v_cvt_pk_bf16_f32 v29, v29, v29
  v_and_b32 v29, 0xffff0000, v29
  v_rcp_f32 v29, v29
  v_sub_f32 v27, v16, v26
  v_sub_f32 v28, v17, v26
  v_cvt_pk_bf16_f32 v30, v27, v28
  v_lshlrev_b32 v27, 16, v30
  v_and_b32 v28, 0xffff0000, v30
  v_mul_f32 v27, v27, v29
  v_mul_f32 v28, v28, v29
  v_cvt_pk_bf16_f32 v16, v27, v27
  v_cvt_pk_bf16_f32 v17, v28, v28
  v_sub_f32 v27, v18, v26
  v_sub_f32 v28, v19, v26
  v_cvt_pk_bf16_f32 v30, v27, v28
  v_lshlrev_b32 v27, 16, v30
  v_and_b32 v28, 0xffff0000, v30
  v_mul_f32 v27, v27, v29
  v_mul_f32 v28, v28, v29
  v_cvt_pk_bf16_f32 v18, v27, v27
  v_cvt_pk_bf16_f32 v19, v28, v28
  v_sub_f32 v27, v20, v26
  v_sub_f32 v28, v21, v26
  v_cvt_pk_bf16_f32 v30, v27, v28
  v_lshlrev_b32 v27, 16, v30
  v_and_b32 v28, 0xffff0000, v30
  v_mul_f32 v27, v27, v29
  v_mul_f32 v28, v28, v29
  v_cvt_pk_bf16_f32 v20, v27, v27
  v_cvt_pk_bf16_f32 v21, v28, v28
  v_sub_f32 v27, v22, v26
  v_sub_f32 v28, v23, v26
  v_cvt_pk_bf16_f32 v30, v27, v28
  v_lshlrev_b32 v27, 16, v30
  v_and_b32 v28, 0xffff0000, v30
  v_mul_f32 v27, v27, v29
  v_mul_f32 v28, v28, v29
  v_cvt_pk_bf16_f32 v22, v27, v27
  v_cvt_pk_bf16_f32 v23, v28, v28
  v_sub_f32 v27, v24, v26
  v_sub_f32 v28, v25, v26
  v_cvt_pk_bf16_f32 v30, v27, v28
  v_lshlrev_b32 v27, 16, v30
  v_and_b32 v28, 0xffff0000, v30
  v_mul_f32 v27, v27, v29
  v_mul_f32 v28, v28, v29
  v_cvt_pk_bf16_f32 v24, v27, v27
  v_cvt_pk_bf16_f32 v25, v28, v28
  ds_write_b64 v6, v[16:17] offset:0
  ds_write_b64 v6, v[18:19] offset:512
  ds_write_b64 v6, v[20:21] offset:1024
  ds_write_b64 v6, v[22:23] offset:1536
  ds_write_b64 v6, v[24:25] offset:2048
  s_waitcnt lgkmcnt(0)
  ds_read_b128 v[52:55], v7 offset:0
  ds_read_b128 v[56:59], v7 offset:16
  ds_read_b128 v[60:63], v7 offset:32
  ds_read_b128 v[64:67], v7 offset:48
  ds_read_b128 v[68:71], v7 offset:64
  s_waitcnt lgkmcnt(0)
  s_add_u32 s30, s30, 1540483477
  s_add_u32 s31, s31, 625341585
  s_waitcnt vmcnt(16)
  v_and_b32 v36, v52, v32
  v_and_b32 v37, v52, v33
  v_and_b32 v38, v52, v34
  v_and_b32 v39, v52, v35
  s_nop 1
  v_mfma_f32_16x16x32_bf16 v[44:47], v[36:39], v[100:103], 0
  v_and_b32 v40, v53, v32
  v_and_b32 v41, v53, v33
  v_and_b32 v42, v53, v34
  v_and_b32 v43, v53, v35
  s_nop 1
  v_mfma_f32_16x16x32_bf16 v[48:51], v[40:43], v[104:107], 0
  v_and_b32 v36, v54, v32
  v_and_b32 v37, v54, v33
  v_and_b32 v38, v54, v34
  v_and_b32 v39, v54, v35
  s_nop 1
  v_mfma_f32_16x16x32_bf16 v[44:47], v[36:39], v[108:111], v[44:47]
  v_and_b32 v40, v55, v32
  v_and_b32 v41, v55, v33
  v_and_b32 v42, v55, v34
  v_and_b32 v43, v55, v35
  s_nop 1
  v_mfma_f32_16x16x32_bf16 v[48:51], v[40:43], v[112:115], v[48:51]
  v_and_b32 v36, v56, v32
  v_and_b32 v37, v56, v33
  v_and_b32 v38, v56, v34
  v_and_b32 v39, v56, v35
  s_nop 1
  v_mfma_f32_16x16x32_bf16 v[44:47], v[36:39], v[116:119], v[44:47]
  s_waitcnt vmcnt(11)
  v_and_b32 v40, v57, v32
  v_and_b32 v41, v57, v33
  v_and_b32 v42, v57, v34
  v_and_b32 v43, v57, v35
  s_nop 1
  v_mfma_f32_16x16x32_bf16 v[48:51], v[40:43], v[120:123], v[48:51]
  v_and_b32 v36, v58, v32
  v_and_b32 v37, v58, v33
  v_and_b32 v38, v58, v34
  v_and_b32 v39, v58, v35
  s_nop 1
  v_mfma_f32_16x16x32_bf16 v[44:47], v[36:39], v[124:127], v[44:47]
  v_and_b32 v40, v59, v32
  v_and_b32 v41, v59, v33
  v_and_b32 v42, v59, v34
  v_and_b32 v43, v59, v35
  s_nop 1
  v_mfma_f32_16x16x32_bf16 v[48:51], v[40:43], v[128:131], v[48:51]
  v_and_b32 v36, v60, v32
  v_and_b32 v37, v60, v33
  v_and_b32 v38, v60, v34
  v_and_b32 v39, v60, v35
  s_nop 1
  v_mfma_f32_16x16x32_bf16 v[44:47], v[36:39], v[132:135], v[44:47]
  v_and_b32 v40, v61, v32
  v_and_b32 v41, v61, v33
  v_and_b32 v42, v61, v34
  v_and_b32 v43, v61, v35
  s_nop 1
  v_mfma_f32_16x16x32_bf16 v[48:51], v[40:43], v[136:139], v[48:51]
  s_waitcnt vmcnt(6)
  v_and_b32 v36, v62, v32
  v_and_b32 v37, v62, v33
  v_and_b32 v38, v62, v34
  v_and_b32 v39, v62, v35
  s_nop 1
  v_mfma_f32_16x16x32_bf16 v[44:47], v[36:39], v[140:143], v[44:47]
  v_and_b32 v40, v63, v32
  v_and_b32 v41, v63, v33
  v_and_b32 v42, v63, v34
  v_and_b32 v43, v63, v35
  s_nop 1
  v_mfma_f32_16x16x32_bf16 v[48:51], v[40:43], v[144:147], v[48:51]
  v_and_b32 v36, v64, v32
  v_and_b32 v37, v64, v33
  v_and_b32 v38, v64, v34
  v_and_b32 v39, v64, v35
  s_nop 1
  v_mfma_f32_16x16x32_bf16 v[44:47], v[36:39], v[148:151], v[44:47]
  v_and_b32 v40, v65, v32
  v_and_b32 v41, v65, v33
  v_and_b32 v42, v65, v34
  v_and_b32 v43, v65, v35
  s_nop 1
  v_mfma_f32_16x16x32_bf16 v[48:51], v[40:43], v[152:155], v[48:51]
  v_and_b32 v36, v66, v32
  v_and_b32 v37, v66, v33
  v_and_b32 v38, v66, v34
  v_and_b32 v39, v66, v35
  s_nop 1
  v_mfma_f32_16x16x32_bf16 v[44:47], v[36:39], v[156:159], v[44:47]
  s_waitcnt vmcnt(1)
  v_and_b32 v40, v67, v32
  v_and_b32 v41, v67, v33
  v_and_b32 v42, v67, v34
  v_and_b32 v43, v67, v35
  s_nop 1
  v_mfma_f32_16x16x32_bf16 v[48:51], v[40:43], v[160:163], v[48:51]
  v_and_b32 v36, v68, v32
  v_and_b32 v37, v68, v33
  v_and_b32 v38, v68, v34
  v_and_b32 v39, v68, v35
  s_nop 1
  v_mfma_f32_16x16x32_bf16 v[44:47], v[36:39], v[164:167], v[44:47]
  v_and_b32 v40, v69, v32
  v_and_b32 v41, v69, v33
  v_and_b32 v42, v69, v34
  v_and_b32 v43, v69, v35
  s_nop 1
  v_mfma_f32_16x16x32_bf16 v[48:51], v[40:43], v[168:171], v[48:51]
  v_and_b32 v36, v70, v32
  v_and_b32 v37, v70, v33
  v_and_b32 v38, v70, v34
  v_and_b32 v39, v70, v35
  s_nop 1
  v_mfma_f32_16x16x32_bf16 v[44:47], v[36:39], v[172:175], v[44:47]
  v_and_b32 v40, v71, v32
  v_and_b32 v41, v71, v33
  v_and_b32 v42, v71, v34
  v_and_b32 v43, v71, v35
  s_nop 1
  v_mfma_f32_16x16x32_bf16 v[48:51], v[40:43], v[176:179], v[48:51]
  s_nop 7
  v_add_f32 v44, v44, v48
  v_add_f32 v45, v45, v49
  v_add_f32 v46, v46, v50
  v_add_f32 v47, v47, v51
  v_mov_b32 v26, v44
  v_mov_b32 v27, v45
  v_mov_b32 v28, v46
  v_mov_b32 v29, v47
  v_permlane32_swap_b32 v44, v26
  v_permlane32_swap_b32 v45, v27
  v_permlane32_swap_b32 v46, v28
  v_permlane32_swap_b32 v47, v29
  v_add_f32_dpp v44, v26, v44 row_ror:8 row_mask:0xf bank_mask:0xf
  v_add_f32_dpp v45, v27, v45 row_ror:8 row_mask:0xf bank_mask:0xf
  v_add_f32_dpp v46, v28, v46 row_ror:8 row_mask:0xf bank_mask:0xf
  v_add_f32_dpp v47, v29, v47 row_ror:8 row_mask:0xf bank_mask:0xf
  s_nop 0
  v_mov_b32_dpp v44, v46 row_ror:8 row_mask:0xf bank_mask:0xc
  v_mov_b32_dpp v45, v47 row_ror:8 row_mask:0xf bank_mask:0xc
  v_and_b32 v8, 7, v5
  v_lshlrev_b32 v8, 6, v8
  v_lshl_add_u32 v8, v4, 5, v8
  v_lshrrev_b32 v9, 3, v5
  v_lshl_add_u32 v8, v9, 4, v8
  s_lshl_b32 s57, s32, 12
  s_lshl_b32 s58, s58, 10
  s_add_u32 s57, s57, s58
  s_lshl_b32 s59, s59, 9
  s_add_u32 s57, s57, s59
  s_add_u32 s57, s57, 65536
  v_mov_b32 v72, v44
  v_mov_b32 v73, s30
  v_mov_b32 v74, v45
  v_mov_b32 v75, s31
  s_waitcnt vmcnt(0)
  s_mov_b32 exec_hi, 0
  buffer_store_dwordx4 v[72:75], v8, s[36:39], s57 offen sc1
  s_mov_b64 exec, -1
  v_lshlrev_b32 v9, 4, v0
  s_lshl_b32 s58, s32, 12
  s_add_u32 s58, s58, 65536
  s_waitcnt vmcnt(0)
L_H0_POLL:
  buffer_load_dwordx4 v[72:75], v9, s[36:39], s58 offen offset:0 sc1
  buffer_load_dwordx4 v[76:79], v9, s[36:39], s58 offen offset:1024 sc1
  buffer_load_dwordx4 v[80:83], v9, s[36:39], s58 offen offset:2048 sc1
  buffer_load_dwordx4 v[84:87], v9, s[36:39], s58 offen offset:3072 sc1
  s_waitcnt vmcnt(0)
  v_xor_b32 v26, s30, v73
  v_bitop3_b32 v26, v26, v75, s31 bitop3:0xf6
  v_bitop3_b32 v26, v26, v77, s30 bitop3:0xf6
  v_bitop3_b32 v26, v26, v79, s31 bitop3:0xf6
  v_bitop3_b32 v26, v26, v81, s30 bitop3:0xf6
  v_bitop3_b32 v26, v26, v83, s31 bitop3:0xf6
  v_bitop3_b32 v26, v26, v85, s30 bitop3:0xf6
  v_bitop3_b32 v26, v26, v87, s31 bitop3:0xf6
  v_cmp_ne_u32 vcc, 0, v26
  s_cbranch_vccz L_H0_POLL_OK
  s_add_u32 s80, s80, 1
  s_cmp_lt_u32 s80, 200000
  s_cbranch_scc1 L_H0_POLL
L_H0_POLL_OK:
  v_add_f32 v26, v72, v76
  v_add_f32 v27, v74, v78
  v_add_f32 v26, v26, v80
  v_add_f32 v27, v27, v82
  v_add_f32 v26, v26, v84
  v_add_f32 v27, v27, v86
  v_cvt_pk_bf16_f32 v26, v26, v27
  v_lshlrev_b32 v6, 2, v0
  ds_write_b32 v6, v26 offset:5120
  v_mov_b32 v7, 0
  v_mov_b32 v8, 1
  s_waitcnt lgkmcnt(0)
  ds_write_b32 v7, v8 offset:7936
  s_mov_b32 s60, 0
  s_mov_b32 s61, 0
  s_mov_b32 s82, 0
  v_lshlrev_b32 v6, 2, v0
  v_mov_b32 v9, 1073741824
  s_mov_b32 s63, 64
  s_add_u32 s66, s28, s70
  s_addc_u32 s67, s29, 0
  s_and_b32 s71, s32, 0
  s_bcnt1_i32_b32 s71, s71
L_M_LOOP:
L_M_SPIN_S:
  ds_read_b32 v2, v7 offset:7944
  s_waitcnt lgkmcnt(0)
  v_readfirstlane_b32 s62, v2
  s_add_u32 s62, s62, 5
  s_sub_u32 s62, s62, s60
  s_cmp_ge_i32 s62, 122
  s_cbranch_scc1 L_M_SPIN_S_OK
  s_add_u32 s82, s82, 1
  s_cmp_lt_u32 s82, 3200000
  s_cbranch_scc1 L_M_SPIN_S
L_M_SPIN_S_OK:
  s_sub_u32 s65, s62, 120
  s_min_u32 s65, s65, 32
  s_mov_b32 s64, s65
  s_atomic_add s64, s[66:67], 0x0 glc
  s_add_u32 s60, s60, s65
  s_bfm_b64 s[68:69], s65, 0
  s_waitcnt lgkmcnt(0)
  v_add_u32 v3, s64, v0
  v_and_b32 v10, 7, v3
  v_lshrrev_b32 v8, 3, v3
  v_add_u32 v12, 120, v8
  v_bfe_u32 v8, v12, 0, 1
  v_lshlrev_b32 v8, 1, v8
  v_bfe_u32 v11, v12, 1, 2
  v_lshl_or_b32 v8, v11, 3, v8
  v_bfe_u32 v11, v12, 3, 1
  v_lshl_or_b32 v8, v11, 2, v8
  v_bfe_u32 v11, v12, 4, 1
  v_lshl_or_b32 v8, v11, 0, v8
  v_bfe_u32 v11, v12, 5, 2
  v_lshl_or_b32 v8, v11, 5, v8
  v_lshl_add_u32 v8, v10, 7, v8
  v_and_b32 v11, 1, v10
  v_bcnt_u32_b32 v11, v11, s71
  v_and_b32 v11, 1, v11
  v_lshlrev_b32 v11, 6, v11
  v_xor_b32 v8, v8, v11
  v_lshlrev_b32 v8, 12, v8
  v_cmp_gt_u32 vcc, s63, v3
  s_nop 1
  v_cndmask_b32 v8, v9, v8, vcc
  s_add_u32 s61, s61, s65
  s_add_u32 s64, s64, s65
  s_cmp_gt_u32 s64, 64
  s_cselect_b64 exec, -1, s[68:69]
  ds_write_b32 v6, v8 offset:8192
  s_mov_b64 exec, -1
  s_cbranch_scc1 L_M_DONE_X
  s_lshl_b32 s65, s65, 2
  v_add_u32 v6, s65, v6
  s_branch L_M_LOOP
L_M_DONE_X:
  s_waitcnt vmcnt(0) lgkmcnt(0)
  s_and_b32 s72, s30, 0xff
  s_bfe_u32 s73, s30, 0x80008
  s_bfe_u32 s74, s30, 0x80010
  s_lshr_b32 s75, s30, 24
  v_and_b32 v2, 31, v0
  v_lshlrev_b32 v2, 4, v2
  v_mov_b32 v10, 0
  v_mov_b32 v15, 0xff
  s_lshl_b32 s60, s2, 9
  s_add_u32 s60, s60, 262144
  s_lshl_b32 s61, s32, 7
  s_add_u32 s61, s61, 393216
  s_lshl_b32 s62, s33, 4
  s_add_u32 s62, s62, s61
  s_mov_b32 s82, 0
L_H0_CW:
  v_mov_b32 v3, 0
  ds_read_b32 v3, v3 offset:7952
  s_waitcnt lgkmcnt(0)
  v_readfirstlane_b32 s81, v3
  s_cmp_ge_u32 s81, 4
  s_cbranch_scc1 L_H0_CW_OK
  s_add_u32 s82, s82, 1
  s_cmp_lt_u32 s82, 3200000
  s_cbranch_scc1 L_H0_CW
L_H0_CW_OK:
  ds_read_b64 v[32:33], v10 offset:5888
  ds_read_b64 v[34:35], v10 offset:6464
  ds_read_b64 v[36:37], v10 offset:7040
  ds_read_b64 v[38:39], v10 offset:7616
  ds_read_b128 v[16:19], v2 offset:5376
  ds_read_b128 v[20:23], v2 offset:5952
  ds_read_b128 v[24:27], v2 offset:6528
  ds_read_b128 v[28:31], v2 offset:7104
  s_waitcnt lgkmcnt(4)
  v_max3_f32 v8, v32, v34, v36
  v_max_f32 v8, v8, v38
  v_sub_f32 v32, v32, v8
  v_sub_f32 v34, v34, v8
  v_sub_f32 v36, v36, v8
  v_sub_f32 v38, v38, v8
  v_mul_f32 v32, 0x3fb8aa3b, v32
  v_mul_f32 v34, 0x3fb8aa3b, v34
  v_mul_f32 v36, 0x3fb8aa3b, v36
  v_mul_f32 v38, 0x3fb8aa3b, v38
  v_exp_f32 v32, v32
  v_exp_f32 v34, v34
  v_exp_f32 v36, v36
  v_exp_f32 v38, v38
  v_mov_b32 v84, v8
  v_mov_b32 v85, s30
  v_mov_b32 v87, s31
  v_mul_f32 v86, v32, v33
  v_fmac_f32 v86, v34, v35
  v_fmac_f32 v86, v36, v37
  v_fmac_f32 v86, v38, v39
  s_waitcnt lgkmcnt(0)
  v_mul_f32 v80, v32, v16
  v_mul_f32 v81, v32, v17
  v_mul_f32 v82, v32, v18
  v_mul_f32 v83, v32, v19
  v_fmac_f32 v80, v34, v20
  v_fmac_f32 v81, v34, v21
  v_fmac_f32 v82, v34, v22
  v_fmac_f32 v83, v34, v23
  v_fmac_f32 v80, v36, v24
  v_fmac_f32 v81, v36, v25
  v_fmac_f32 v82, v36, v26
  v_fmac_f32 v83, v36, v27
  v_fmac_f32 v80, v38, v28
  v_fmac_f32 v81, v38, v29
  v_fmac_f32 v82, v38, v30
  v_fmac_f32 v83, v38, v31
  v_bfi_b32 v80, v15, s72, v80
  v_bfi_b32 v81, v15, s73, v81
  v_bfi_b32 v82, v15, s74, v82
  v_bfi_b32 v83, v15, s75, v83
  s_mov_b32 exec_hi, 0
  buffer_store_dwordx4 v[80:83], v2, s[36:39], s60 offen sc1
  s_mov_b64 exec, 1
  buffer_store_dwordx4 v[84:87], v10, s[36:39], s62 offen sc1
  s_mov_b64 exec, -1
  s_endpgm
L_H1:
  v_mov_b32 v2, 0
  ds_write_b32 v2, v2 offset:7936
  v_mov_b32 v3, 24
  ds_write_b32 v2, v3 offset:7944
  ds_write_b32 v2, v2 offset:7952
  ds_write_b32 v2, v2 offset:7968
  v_lshlrev_b32 v2, 4, v0
  v_mov_b32 v8, -1
  v_mov_b32 v9, -1
  v_mov_b32 v10, -1
  v_mov_b32 v11, -1
  ds_write_b128 v2, v[8:11] offset:8192
  ds_write_b128 v2, v[8:11] offset:9216
  s_waitcnt lgkmcnt(0)
  s_barrier
  s_lshr_b32 s57, s2, 6
  s_and_b32 s35, s32, 7
  s_mul_i32 s57, s2, 135
  s_add_u32 s58, s57, 135
  s_lshr_b32 s57, s57, 8
  s_lshr_b32 s58, s58, 8
  s_cmp_eq_u32 s57, s58
  s_cbranch_scc1 L_H1_EXIT
  s_mul_i32 s34, s57, 52429
  s_lshr_b32 s34, s34, 18
  s_mul_i32 s58, s34, 5
  s_sub_u32 s35, s57, s58
L_H1_MLP:
  s_waitcnt lgkmcnt(0)
  s_add_u32 s30, s30, 1540483477
  s_add_u32 s31, s31, 625341585
  s_and_b32 s72, s30, 0xff
  s_bfe_u32 s73, s30, 0x80008
  s_bfe_u32 s74, s30, 0x80010
  s_lshr_b32 s75, s30, 24
  s_mov_b32 s82, 0
L_H1_QW:
  v_mov_b32 v2, 0
  ds_read_b32 v2, v2 offset:7936
  s_waitcnt lgkmcnt(0)
  v_readfirstlane_b32 s81, v2
  s_cmp_lg_u32 s81, 0
  s_cbranch_scc1 L_H1_QW_OK
  s_add_u32 s82, s82, 1
  s_cmp_lt_u32 s82, 3200000
  s_cbranch_scc1 L_H1_QW
L_H1_QW_OK:
  s_mov_b32 s44, s16
  s_mov_b32 s45, s17
  s_mov_b32 s46, 2211840
  s_mov_b32 s47, 0x20000
  s_mov_b32 s48, s20
  s_mov_b32 s49, s21
  s_mov_b32 s50, 2211840
  s_mov_b32 s51, 0x20000
  s_mov_b32 s52, s18
  s_mov_b32 s53, s19
  s_mov_b32 s54, 3456
  s_mov_b32 s55, 0x20000
  v_lshlrev_b32 v6, 3, v0
  ds_read_b64 v[16:17], v6 offset:0
  ds_read_b64 v[18:19], v6 offset:512
  ds_read_b64 v[20:21], v6 offset:1024
  ds_read_b64 v[22:23], v6 offset:1536
  ds_read_b64 v[24:25], v6 offset:2048
  v_bfe_u32 v10, v0, 3, 1
  v_and_b32 v7, 7, v0
  v_mul_u32_u24 v8, 32, v4
  v_mad_u32_u24 v8, v10, 16, v8
  v_mul_u32_u24 v3, 3456, v8
  v_lshl_add_u32 v3, v7, 4, v3
  s_mul_i32 s56, s35, 442368
  s_lshl_b32 s57, s34, 7
  s_add_u32 s56, s56, s57
  buffer_load_dwordx4 v[100:103], v3, s[44:47], s56 offen nt
  s_add_u32 s56, s56, 3456
  buffer_load_dwordx4 v[104:107], v3, s[44:47], s56 offen nt
  s_add_u32 s56, s56, 3456
  buffer_load_dwordx4 v[108:111], v3, s[44:47], s56 offen nt
  s_add_u32 s56, s56, 3456
  buffer_load_dwordx4 v[112:115], v3, s[44:47], s56 offen nt
  s_add_u32 s56, s56, 3456
  buffer_load_dwordx4 v[116:119], v3, s[44:47], s56 offen nt
  s_add_u32 s56, s56, 3456
  buffer_load_dwordx4 v[120:123], v3, s[44:47], s56 offen nt
  s_add_u32 s56, s56, 3456
  buffer_load_dwordx4 v[124:127], v3, s[44:47], s56 offen nt
  s_add_u32 s56, s56, 3456
  buffer_load_dwordx4 v[128:131], v3, s[44:47], s56 offen nt
  s_add_u32 s56, s56, 3456
  buffer_load_dwordx4 v[132:135], v3, s[44:47], s56 offen nt
  s_add_u32 s56, s56, 3456
  buffer_load_dwordx4 v[136:139], v3, s[44:47], s56 offen nt
  s_add_u32 s56, s56, 3456
  buffer_load_dwordx4 v[140:143], v3, s[44:47], s56 offen nt
  s_add_u32 s56, s56, 3456
  buffer_load_dwordx4 v[144:147], v3, s[44:47], s56 offen nt
  s_add_u32 s56, s56, 3456
  buffer_load_dwordx4 v[148:151], v3, s[44:47], s56 offen nt
  s_add_u32 s56, s56, 3456
  buffer_load_dwordx4 v[152:155], v3, s[44:47], s56 offen nt
  s_add_u32 s56, s56, 3456
  buffer_load_dwordx4 v[156:159], v3, s[44:47], s56 offen nt
  s_add_u32 s56, s56, 3456
  buffer_load_dwordx4 v[160:163], v3, s[44:47], s56 offen nt
  v_lshlrev_b32 v11, 3, v5
  buffer_load_dwordx2 v[14:15], v11, s[52:55], s57 offen
  v_mul_u32_u24 v3, 20480, v4
  v_lshl_add_u32 v3, v5, 4, v3
  v_mov_b32 v11, 1073741824
  v_and_b32 v26, 1, v0
  v_cmp_eq_u32 vcc, 1, v26
  v_mov_b32 v26, 0x0000ffff
  v_mov_b32 v27, 0xffff0000
  v_cndmask_b32 v26, v26, v27, vcc
  v_and_b32 v27, 7, v0
  v_lshrrev_b32 v27, 1, v27
  v_cmp_eq_u32 vcc, 0, v27
  s_nop 1
  v_cndmask_b32 v32, 0, v26, vcc
  v_cmp_eq_u32 vcc, 1, v27
  s_nop 1
  v_cndmask_b32 v33, 0, v26, vcc
  v_cmp_eq_u32 vcc, 2, v27
  s_nop 1
  v_cndmask_b32 v34, 0, v26, vcc
  v_cmp_eq_u32 vcc, 3, v27
  s_nop 1
  v_cndmask_b32 v35, 0, v26, vcc
  s_mul_i32 s57, s35, 512
  v_lshlrev_b32 v8, 2, v8
  v_add_u32 v8, s57, v8
  v_mov_b32 v9, 0xff
  s_waitcnt lgkmcnt(0)
  v_and_b32 v16, 0xffff0000, v16
  v_and_b32 v17, 0xffff0000, v17
  v_and_b32 v18, 0xffff0000, v18
  v_and_b32 v19, 0xffff0000, v19
  v_and_b32 v20, 0xffff0000, v20
  v_and_b32 v21, 0xffff0000, v21
  v_and_b32 v22, 0xffff0000, v22
  v_and_b32 v23, 0xffff0000, v23
  v_and_b32 v24, 0xffff0000, v24
  v_and_b32 v25, 0xffff0000, v25
  v_add_f32 v26, v16, v17
  v_add_f32 v26, v26, v18
  v_add_f32 v26, v26, v19
  v_add_f32 v26, v26, v20
  v_add_f32 v26, v26, v21
  v_add_f32 v26, v26, v22
  v_add_f32 v26, v26, v23
  v_add_f32 v26, v26, v24
  v_add_f32 v26, v26, v25
  s_nop 1
  v_add_f32_dpp v26, v26, v26 row_ror:8 row_mask:0xf bank_mask:0xf
  s_nop 1
  v_add_f32_dpp v26, v26, v26 row_ror:4 row_mask:0xf bank_mask:0xf
  s_nop 1
  v_add_f32_dpp v26, v26, v26 row_ror:2 row_mask:0xf bank_mask:0xf
  s_nop 1
  v_add_f32_dpp v26, v26, v26 row_ror:1 row_mask:0xf bank_mask:0xf
  v_mov_b32 v27, v26
  s_nop 1
  v_permlane16_swap_b32 v26, v27
  v_add_f32 v26, v26, v27
  v_mov_b32 v27, v26
  s_nop 1
  v_permlane32_swap_b32 v26, v27
  v_add_f32 v26, v26, v27
  v_mul_f32 v26, 0x3acccccd, v26
  v_sub_f32 v28, v16, v26
  v_mul_f32 v29, v28, v28
  v_sub_f32 v28, v17, v26
  v_fmac_f32 v29, v28, v28
  v_sub_f32 v28, v18, v26
  v_fmac_f32 v29, v28, v28
  v_sub_f32 v28, v19, v26
  v_fmac_f32 v29, v28, v28
  v_sub_f32 v28, v20, v26
  v_fmac_f32 v29, v28, v28
  v_sub_f32 v28, v21, v26
  v_fmac_f32 v29, v28, v28
  v_sub_f32 v28, v22, v26
  v_fmac_f32 v29, v28, v28
  v_sub_f32 v28, v23, v26
  v_fmac_f32 v29, v28, v28
  v_sub_f32 v28, v24, v26
  v_fmac_f32 v29, v28, v28
  v_sub_f32 v28, v25, v26
  v_fmac_f32 v29, v28, v28
  s_nop 1
  v_add_f32_dpp v29, v29, v29 row_ror:8 row_mask:0xf bank_mask:0xf
  s_nop 1
  v_add_f32_dpp v29, v29, v29 row_ror:4 row_mask:0xf bank_mask:0xf
  s_nop 1
  v_add_f32_dpp v29, v29, v29 row_ror:2 row_mask:0xf bank_mask:0xf
  s_nop 1
  v_add_f32_dpp v29, v29, v29 row_ror:1 row_mask:0xf bank_mask:0xf
  v_mov_b32 v27, v29
  s_nop 1
  v_permlane16_swap_b32 v29, v27
  v_add_f32 v29, v29, v27
  v_mov_b32 v27, v29
  s_nop 1
  v_permlane32_swap_b32 v29, v27
  v_add_f32 v29, v29, v27
  v_mul_f32 v29, 0x3acccccd, v29
  v_cvt_pk_bf16_f32 v29, v29, v29
  v_and_b32 v29, 0xffff0000, v29
  v_add_f32 v29, 0x3727c5ac, v29
  v_cvt_pk_bf16_f32 v29, v29, v29
  v_and_b32 v29, 0xffff0000, v29
  v_sqrt_f32 v29, v29
  v_cvt_pk_bf16_f32 v26, v26, v26
  v_and_b32 v26, 0xffff0000, v26
  v_cvt_pk_bf16_f32 v29, v29, v29
  v_and_b32 v29, 0xffff0000, v29
  v_rcp_f32 v29, v29
  v_sub_f32 v27, v16, v26
  v_sub_f32 v28, v17, v26
  v_cvt_pk_bf16_f32 v30, v27, v28
  v_lshlrev_b32 v27, 16, v30
  v_and_b32 v28, 0xffff0000, v30
  v_mul_f32 v27, v27, v29
  v_mul_f32 v28, v28, v29
  v_cvt_pk_bf16_f32 v16, v27, v27
  v_cvt_pk_bf16_f32 v17, v28, v28
  v_sub_f32 v27, v18, v26
  v_sub_f32 v28, v19, v26
  v_cvt_pk_bf16_f32 v30, v27, v28
  v_lshlrev_b32 v27, 16, v30
  v_and_b32 v28, 0xffff0000, v30
  v_mul_f32 v27, v27, v29
  v_mul_f32 v28, v28, v29
  v_cvt_pk_bf16_f32 v18, v27, v27
  v_cvt_pk_bf16_f32 v19, v28, v28
  v_sub_f32 v27, v20, v26
  v_sub_f32 v28, v21, v26
  v_cvt_pk_bf16_f32 v30, v27, v28
  v_lshlrev_b32 v27, 16, v30
  v_and_b32 v28, 0xffff0000, v30
  v_mul_f32 v27, v27, v29
  v_mul_f32 v28, v28, v29
  v_cvt_pk_bf16_f32 v20, v27, v27
  v_cvt_pk_bf16_f32 v21, v28, v28
  v_sub_f32 v27, v22, v26
  v_sub_f32 v28, v23, v26
  v_cvt_pk_bf16_f32 v30, v27, v28
  v_lshlrev_b32 v27, 16, v30
  v_and_b32 v28, 0xffff0000, v30
  v_mul_f32 v27, v27, v29
  v_mul_f32 v28, v28, v29
  v_cvt_pk_bf16_f32 v22, v27, v27
  v_cvt_pk_bf16_f32 v23, v28, v28
  v_sub_f32 v27, v24, v26
  v_sub_f32 v28, v25, v26
  v_cvt_pk_bf16_f32 v30, v27, v28
  v_lshlrev_b32 v27, 16, v30
  v_and_b32 v28, 0xffff0000, v30
  v_mul_f32 v27, v27, v29
  v_mul_f32 v28, v28, v29
  v_cvt_pk_bf16_f32 v24, v27, v27
  v_cvt_pk_bf16_f32 v25, v28, v28
  ds_write_b64 v6, v[16:17] offset:2560
  ds_write_b64 v6, v[18:19] offset:3072
  ds_write_b64 v6, v[20:21] offset:3584
  ds_write_b64 v6, v[22:23] offset:4096
  ds_write_b64 v6, v[24:25] offset:4608
  s_waitcnt lgkmcnt(0)
  ds_read_b128 v[52:55], v8 offset:2560
  ds_read_b128 v[56:59], v8 offset:2576
  ds_read_b128 v[60:63], v8 offset:2592
  ds_read_b128 v[64:67], v8 offset:2608
  s_waitcnt lgkmcnt(0)
  s_waitcnt vmcnt(1)
  v_and_b32 v36, v52, v32
  v_and_b32 v37, v52, v33
  v_and_b32 v38, v52, v34
  v_and_b32 v39, v52, v35
  s_nop 1
  v_mfma_f32_16x16x32_bf16 v[44:47], v[36:39], v[100:103], 0
  v_and_b32 v40, v53, v32
  v_and_b32 v41, v53, v33
  v_and_b32 v42, v53, v34
  v_and_b32 v43, v53, v35
  s_nop 1
  v_mfma_f32_16x16x32_bf16 v[48:51], v[40:43], v[104:107], 0
  v_and_b32 v36, v54, v32
  v_and_b32 v37, v54, v33
  v_and_b32 v38, v54, v34
  v_and_b32 v39, v54, v35
  s_nop 1
  v_mfma_f32_16x16x32_bf16 v[44:47], v[36:39], v[108:111], v[44:47]
  v_and_b32 v40, v55, v32
  v_and_b32 v41, v55, v33
  v_and_b32 v42, v55, v34
  v_and_b32 v43, v55, v35
  s_nop 1
  v_mfma_f32_16x16x32_bf16 v[48:51], v[40:43], v[112:115], v[48:51]
  v_and_b32 v36, v56, v32
  v_and_b32 v37, v56, v33
  v_and_b32 v38, v56, v34
  v_and_b32 v39, v56, v35
  s_nop 1
  v_mfma_f32_16x16x32_bf16 v[44:47], v[36:39], v[116:119], v[44:47]
  v_and_b32 v40, v57, v32
  v_and_b32 v41, v57, v33
  v_and_b32 v42, v57, v34
  v_and_b32 v43, v57, v35
  s_nop 1
  v_mfma_f32_16x16x32_bf16 v[48:51], v[40:43], v[120:123], v[48:51]
  v_and_b32 v36, v58, v32
  v_and_b32 v37, v58, v33
  v_and_b32 v38, v58, v34
  v_and_b32 v39, v58, v35
  s_nop 1
  v_mfma_f32_16x16x32_bf16 v[44:47], v[36:39], v[124:127], v[44:47]
  v_and_b32 v40, v59, v32
  v_and_b32 v41, v59, v33
  v_and_b32 v42, v59, v34
  v_and_b32 v43, v59, v35
  s_nop 1
  v_mfma_f32_16x16x32_bf16 v[48:51], v[40:43], v[128:131], v[48:51]
  v_and_b32 v36, v60, v32
  v_and_b32 v37, v60, v33
  v_and_b32 v38, v60, v34
  v_and_b32 v39, v60, v35
  s_nop 1
  v_mfma_f32_16x16x32_bf16 v[44:47], v[36:39], v[132:135], v[44:47]
  v_and_b32 v40, v61, v32
  v_and_b32 v41, v61, v33
  v_and_b32 v42, v61, v34
  v_and_b32 v43, v61, v35
  s_nop 1
  v_mfma_f32_16x16x32_bf16 v[48:51], v[40:43], v[136:139], v[48:51]
  v_and_b32 v36, v62, v32
  v_and_b32 v37, v62, v33
  v_and_b32 v38, v62, v34
  v_and_b32 v39, v62, v35
  s_nop 1
  v_mfma_f32_16x16x32_bf16 v[44:47], v[36:39], v[140:143], v[44:47]
  v_and_b32 v40, v63, v32
  v_and_b32 v41, v63, v33
  v_and_b32 v42, v63, v34
  v_and_b32 v43, v63, v35
  s_nop 1
  v_mfma_f32_16x16x32_bf16 v[48:51], v[40:43], v[144:147], v[48:51]
  v_and_b32 v36, v64, v32
  v_and_b32 v37, v64, v33
  v_and_b32 v38, v64, v34
  v_and_b32 v39, v64, v35
  s_nop 1
  v_mfma_f32_16x16x32_bf16 v[44:47], v[36:39], v[148:151], v[44:47]
  v_and_b32 v40, v65, v32
  v_and_b32 v41, v65, v33
  v_and_b32 v42, v65, v34
  v_and_b32 v43, v65, v35
  s_nop 1
  v_mfma_f32_16x16x32_bf16 v[48:51], v[40:43], v[152:155], v[48:51]
  v_and_b32 v36, v66, v32
  v_and_b32 v37, v66, v33
  v_and_b32 v38, v66, v34
  v_and_b32 v39, v66, v35
  s_nop 1
  v_mfma_f32_16x16x32_bf16 v[44:47], v[36:39], v[156:159], v[44:47]
  v_and_b32 v40, v67, v32
  v_and_b32 v41, v67, v33
  v_and_b32 v42, v67, v34
  v_and_b32 v43, v67, v35
  s_nop 1
  v_mfma_f32_16x16x32_bf16 v[48:51], v[40:43], v[160:163], v[48:51]
  s_nop 7
  v_add_f32 v44, v44, v48
  v_add_f32 v45, v45, v49
  v_add_f32 v46, v46, v50
  v_add_f32 v47, v47, v51
  v_mov_b32 v26, v44
  v_mov_b32 v27, v45
  v_mov_b32 v28, v46
  v_mov_b32 v29, v47
  v_permlane32_swap_b32 v44, v26
  v_permlane32_swap_b32 v45, v27
  v_permlane32_swap_b32 v46, v28
  v_permlane32_swap_b32 v47, v29
  v_add_f32_dpp v44, v26, v44 row_ror:8 row_mask:0xf bank_mask:0xf
  v_add_f32_dpp v45, v27, v45 row_ror:8 row_mask:0xf bank_mask:0xf
  v_add_f32_dpp v46, v28, v46 row_ror:8 row_mask:0xf bank_mask:0xf
  v_add_f32_dpp v47, v29, v47 row_ror:8 row_mask:0xf bank_mask:0xf
  v_bfi_b32 v44, v9, s72, v44
  v_bfi_b32 v45, v9, s73, v45
  v_bfi_b32 v46, v9, s74, v46
  v_bfi_b32 v47, v9, s75, v47
  v_lshlrev_b32 v8, 5, v5
  v_lshl_add_u32 v8, v4, 4, v8
  s_lshl_b32 s57, s34, 3
  s_add_u32 s57, s57, s35
  s_lshl_b32 s57, s57, 8
  s_add_u32 s57, s57, 196608
  s_mov_b32 s60, 0x00ff00ff
  s_mov_b32 s61, 0
  s_mov_b64 exec, s[60:61]
  buffer_store_dwordx4 v[44:47], v8, s[36:39], s57 offen sc1
  s_mov_b64 exec, -1
  v_lshlrev_b32 v10, 4, v0
  s_lshl_b32 s58, s34, 11
  s_add_u32 s58, s58, 196608
  v_mov_b32 v76, 0
  v_mov_b32 v77, 0
  v_mov_b32 v78, 0
  v_mov_b32 v79, 0
  s_waitcnt vmcnt(0)
L_H1_POLL:
  buffer_load_dwordx4 v[72:75], v10, s[36:39], s58 offen sc1
  s_mov_b64 exec, 0xffff
  buffer_load_dwordx4 v[76:79], v10, s[36:39], s58 offen offset:1024 sc1
  s_waitcnt vmcnt(0)
  s_mov_b64 exec, -1
  v_xor_b32 v72, s72, v72
  v_xor_b32 v73, s73, v73
  v_xor_b32 v74, s74, v74
  v_xor_b32 v75, s75, v75
  v_or3_b32 v26, v72, v73, v74
  v_or_b32 v26, v26, v75
  s_mov_b64 exec, 0xffff
  v_xor_b32 v76, s72, v76
  v_xor_b32 v77, s73, v77
  v_xor_b32 v78, s74, v78
  v_xor_b32 v79, s75, v79
  v_or3_b32 v26, v26, v76, v77
  v_or3_b32 v26, v26, v78, v79
  s_mov_b64 exec, -1
  v_and_b32 v26, 0xff, v26
  v_cmp_ne_u32 vcc, 0, v26
  s_cbranch_vccz L_H1_POLL_OK
  s_add_u32 s80, s80, 1
  s_cmp_lt_u32 s80, 200000
  s_cbranch_scc1 L_H1_POLL
L_H1_POLL_OK:
  v_add_f32 v72, v72, v76
  v_add_f32 v73, v73, v77
  v_add_f32 v74, v74, v78
  v_add_f32 v75, v75, v79
  v_mov_b32 v26, v72
  v_mov_b32 v27, v73
  v_mov_b32 v28, v74
  v_mov_b32 v29, v75
  v_permlane16_swap_b32 v72, v26
  v_permlane16_swap_b32 v73, v27
  v_permlane16_swap_b32 v74, v28
  v_permlane16_swap_b32 v75, v29
  v_add_f32 v72, v72, v26
  v_add_f32 v73, v73, v27
  v_add_f32 v74, v74, v28
  v_add_f32 v75, v75, v29
  v_mov_b32 v26, v72
  v_mov_b32 v27, v73
  v_mov_b32 v28, v74
  v_mov_b32 v29, v75
  v_permlane32_swap_b32 v72, v26
  v_permlane32_swap_b32 v73, v27
  v_permlane32_swap_b32 v74, v28
  v_permlane32_swap_b32 v75, v29
  v_add_f32 v72, v72, v26
  v_add_f32 v73, v73, v27
  v_add_f32 v74, v74, v28
  v_add_f32 v75, v75, v29
  s_mov_b32 s62, 0xbdd2d3e8
  v_cvt_pk_bf16_f32 v72, v72, v72
  v_and_b32 v72, 0xffff0000, v72
  v_lshlrev_b32 v28, 16, v14
  v_add_f32 v72, v72, v28
  v_cvt_pk_bf16_f32 v72, v72, v72
  v_and_b32 v72, 0xffff0000, v72
  v_mul_f32 v28, v72, v72
  v_mov_b32 v29, 0xc0135761
  v_fmac_f32 v29, s62, v28
  v_mul_f32 v29, v29, v72
  v_exp_f32 v29, v29
  s_nop 0
  v_add_f32 v29, 1.0, v29
  v_rcp_f32 v29, v29
  s_nop 0
  v_mul_f32 v72, v72, v29
  v_cvt_pk_bf16_f32 v72, v72, v72
  v_cvt_pk_bf16_f32 v73, v73, v73
  v_and_b32 v73, 0xffff0000, v73
  v_and_b32 v28, 0xffff0000, v14
  v_add_f32 v73, v73, v28
  v_cvt_pk_bf16_f32 v73, v73, v73
  v_and_b32 v73, 0xffff0000, v73
  v_mul_f32 v28, v73, v73
  v_mov_b32 v29, 0xc0135761
  v_fmac_f32 v29, s62, v28
  v_mul_f32 v29, v29, v73
  v_exp_f32 v29, v29
  s_nop 0
  v_add_f32 v29, 1.0, v29
  v_rcp_f32 v29, v29
  s_nop 0
  v_mul_f32 v73, v73, v29
  v_cvt_pk_bf16_f32 v73, v73, v73
  v_cvt_pk_bf16_f32 v74, v74, v74
  v_and_b32 v74, 0xffff0000, v74
  v_lshlrev_b32 v28, 16, v15
  v_add_f32 v74, v74, v28
  v_cvt_pk_bf16_f32 v74, v74, v74
  v_and_b32 v74, 0xffff0000, v74
  v_mul_f32 v28, v74, v74
  v_mov_b32 v29, 0xc0135761
  v_fmac_f32 v29, s62, v28
  v_mul_f32 v29, v29, v74
  v_exp_f32 v29, v29
  s_nop 0
  v_add_f32 v29, 1.0, v29
  v_rcp_f32 v29, v29
  s_nop 0
  v_mul_f32 v74, v74, v29
  v_cvt_pk_bf16_f32 v74, v74, v74
  v_cvt_pk_bf16_f32 v75, v75, v75
  v_and_b32 v75, 0xffff0000, v75
  v_and_b32 v28, 0xffff0000, v15
  v_add_f32 v75, v75, v28
  v_cvt_pk_bf16_f32 v75, v75, v75
  v_and_b32 v75, 0xffff0000, v75
  v_mul_f32 v28, v75, v75
  v_mov_b32 v29, 0xc0135761
  v_fmac_f32 v29, s62, v28
  v_mul_f32 v29, v29, v75
  v_exp_f32 v29, v29
  s_nop 0
  v_add_f32 v29, 1.0, v29
  v_rcp_f32 v29, v29
  s_nop 0
  v_mul_f32 v75, v75, v29
  v_cvt_pk_bf16_f32 v75, v75, v75
  v_lshlrev_b32 v6, 4, v5
  ds_write_b128 v6, v[72:75] offset:7680
  v_lshlrev_b32 v7, 6, v4
  s_waitcnt lgkmcnt(0)
  ds_read_b128 v[52:55], v7 offset:7680
  ds_read_b128 v[56:59], v7 offset:7696
  ds_read_b128 v[60:63], v7 offset:7712
  ds_read_b128 v[64:67], v7 offset:7728
  v_and_b32 v28, 1, v0
  v_cmp_eq_u32 vcc, 1, v28
  v_mov_b32 v28, 0x0000ffff
  v_mov_b32 v29, 0xffff0000
  v_cndmask_b32 v28, v28, v29, vcc
  v_and_b32 v29, 15, v0
  v_lshrrev_b32 v29, 1, v29
  v_cmp_eq_u32 vcc, 0, v29
  s_nop 1
  v_cndmask_b32 v32, 0, v28, vcc
  v_cmp_eq_u32 vcc, 1, v29
  s_nop 1
  v_cndmask_b32 v33, 0, v28, vcc
  v_cmp_eq_u32 vcc, 2, v29
  s_nop 1
  v_cndmask_b32 v34, 0, v28, vcc
  v_cmp_eq_u32 vcc, 3, v29
  s_nop 1
  v_cndmask_b32 v35, 0, v28, vcc
  s_waitcnt lgkmcnt(0)
  s_mov_b32 s82, 0
L_H1_CW:
  v_mov_b32 v2, 0
  ds_read_b32 v2, v2 offset:7952
  s_waitcnt lgkmcnt(0)
  v_readfirstlane_b32 s81, v2
  s_cmp_ge_u32 s81, 1
  s_cbranch_scc1 L_H1_CW_OK
  s_add_u32 s82, s82, 1
  s_cmp_lt_u32 s82, 3200000
  s_cbranch_scc1 L_H1_CW
L_H1_CW_OK:
  s_mul_i32 s56, s34, 81920
  s_mul_i32 s57, s35, 256
  s_add_u32 s56, s56, s57
  buffer_load_dwordx4 v[164:167], v3, s[48:51], s56 offen nt
  s_add_u32 s56, s56, 1280
  buffer_load_dwordx4 v[168:171], v3, s[48:51], s56 offen nt
  s_add_u32 s56, s56, 1280
  buffer_load_dwordx4 v[172:175], v3, s[48:51], s56 offen nt
  s_add_u32 s56, s56, 1280
  buffer_load_dwordx4 v[176:179], v3, s[48:51], s56 offen nt
  s_add_u32 s56, s56, 1280
  buffer_load_dwordx4 v[180:183], v3, s[48:51], s56 offen nt
  s_add_u32 s56, s56, 1280
  buffer_load_dwordx4 v[184:187], v3, s[48:51], s56 offen nt
  s_add_u32 s56, s56, 1280
  buffer_load_dwordx4 v[188:191], v3, s[48:51], s56 offen nt
  s_add_u32 s56, s56, 1280
  buffer_load_dwordx4 v[192:195], v3, s[48:51], s56 offen nt
  s_add_u32 s56, s56, 1280
  buffer_load_dwordx4 v[196:199], v3, s[48:51], s56 offen nt
  s_add_u32 s56, s56, 1280
  buffer_load_dwordx4 v[200:203], v3, s[48:51], s56 offen nt
  s_add_u32 s56, s56, 1280
  buffer_load_dwordx4 v[204:207], v3, s[48:51], s56 offen nt
  s_add_u32 s56, s56, 1280
  buffer_load_dwordx4 v[208:211], v3, s[48:51], s56 offen nt
  s_add_u32 s56, s56, 1280
  buffer_load_dwordx4 v[212:215], v3, s[48:51], s56 offen nt
  s_add_u32 s56, s56, 1280
  buffer_load_dwordx4 v[216:219], v3, s[48:51], s56 offen nt
  s_add_u32 s56, s56, 1280
  buffer_load_dwordx4 v[220:223], v3, s[48:51], s56 offen nt
  s_add_u32 s56, s56, 1280
  buffer_load_dwordx4 v[224:227], v3, s[48:51], s56 offen nt
  s_waitcnt vmcnt(12)
  v_and_b32 v36, v52, v32
  v_and_b32 v37, v52, v33
  v_and_b32 v38, v52, v34
  v_and_b32 v39, v52, v35
  s_nop 1
  v_mfma_f32_16x16x32_bf16 v[44:47], v[36:39], v[164:167], 0
  v_and_b32 v40, v53, v32
  v_and_b32 v41, v53, v33
  v_and_b32 v42, v53, v34
  v_and_b32 v43, v53, v35
  s_nop 1
  v_mfma_f32_16x16x32_bf16 v[48:51], v[40:43], v[168:171], 0
  v_and_b32 v36, v54, v32
  v_and_b32 v37, v54, v33
  v_and_b32 v38, v54, v34
  v_and_b32 v39, v54, v35
  s_nop 1
  v_mfma_f32_16x16x32_bf16 v[44:47], v[36:39], v[172:175], v[44:47]
  v_and_b32 v40, v55, v32
  v_and_b32 v41, v55, v33
  v_and_b32 v42, v55, v34
  v_and_b32 v43, v55, v35
  s_nop 1
  v_mfma_f32_16x16x32_bf16 v[48:51], v[40:43], v[176:179], v[48:51]
  s_waitcnt vmcnt(8)
  v_and_b32 v36, v56, v32
  v_and_b32 v37, v56, v33
  v_and_b32 v38, v56, v34
  v_and_b32 v39, v56, v35
  s_nop 1
  v_mfma_f32_16x16x32_bf16 v[44:47], v[36:39], v[180:183], v[44:47]
  v_and_b32 v40, v57, v32
  v_and_b32 v41, v57, v33
  v_and_b32 v42, v57, v34
  v_and_b32 v43, v57, v35
  s_nop 1
  v_mfma_f32_16x16x32_bf16 v[48:51], v[40:43], v[184:187], v[48:51]
  v_and_b32 v36, v58, v32
  v_and_b32 v37, v58, v33
  v_and_b32 v38, v58, v34
  v_and_b32 v39, v58, v35
  s_nop 1
  v_mfma_f32_16x16x32_bf16 v[44:47], v[36:39], v[188:191], v[44:47]
  v_and_b32 v40, v59, v32
  v_and_b32 v41, v59, v33
  v_and_b32 v42, v59, v34
  v_and_b32 v43, v59, v35
  s_nop 1
  v_mfma_f32_16x16x32_bf16 v[48:51], v[40:43], v[192:195], v[48:51]
  s_waitcnt vmcnt(4)
  v_and_b32 v36, v60, v32
  v_and_b32 v37, v60, v33
  v_and_b32 v38, v60, v34
  v_and_b32 v39, v60, v35
  s_nop 1
  v_mfma_f32_16x16x32_bf16 v[44:47], v[36:39], v[196:199], v[44:47]
  v_and_b32 v40, v61, v32
  v_and_b32 v41, v61, v33
  v_and_b32 v42, v61, v34
  v_and_b32 v43, v61, v35
  s_nop 1
  v_mfma_f32_16x16x32_bf16 v[48:51], v[40:43], v[200:203], v[48:51]
  v_and_b32 v36, v62, v32
  v_and_b32 v37, v62, v33
  v_and_b32 v38, v62, v34
  v_and_b32 v39, v62, v35
  s_nop 1
  v_mfma_f32_16x16x32_bf16 v[44:47], v[36:39], v[204:207], v[44:47]
  v_and_b32 v40, v63, v32
  v_and_b32 v41, v63, v33
  v_and_b32 v42, v63, v34
  v_and_b32 v43, v63, v35
  s_nop 1
  v_mfma_f32_16x16x32_bf16 v[48:51], v[40:43], v[208:211], v[48:51]
  s_waitcnt vmcnt(0)
  v_and_b32 v36, v64, v32
  v_and_b32 v37, v64, v33
  v_and_b32 v38, v64, v34
  v_and_b32 v39, v64, v35
  s_nop 1
  v_mfma_f32_16x16x32_bf16 v[44:47], v[36:39], v[212:215], v[44:47]
  v_and_b32 v40, v65, v32
  v_and_b32 v41, v65, v33
  v_and_b32 v42, v65, v34
  v_and_b32 v43, v65, v35
  s_nop 1
  v_mfma_f32_16x16x32_bf16 v[48:51], v[40:43], v[216:219], v[48:51]
  v_and_b32 v36, v66, v32
  v_and_b32 v37, v66, v33
  v_and_b32 v38, v66, v34
  v_and_b32 v39, v66, v35
  s_nop 1
  v_mfma_f32_16x16x32_bf16 v[44:47], v[36:39], v[220:223], v[44:47]
  v_and_b32 v40, v67, v32
  v_and_b32 v41, v67, v33
  v_and_b32 v42, v67, v34
  v_and_b32 v43, v67, v35
  s_nop 1
  v_mfma_f32_16x16x32_bf16 v[48:51], v[40:43], v[224:227], v[48:51]
  s_nop 7
  v_add_f32 v44, v44, v48
  v_add_f32 v45, v45, v49
  v_add_f32 v46, v46, v50
  v_add_f32 v47, v47, v51
  v_bfi_b32 v44, v9, s72, v44
  v_bfi_b32 v45, v9, s73, v45
  v_bfi_b32 v46, v9, s74, v46
  v_bfi_b32 v47, v9, s75, v47
  s_mul_i32 s57, s34, 5
  s_add_u32 s57, s57, s35
  s_mul_i32 s57, s57, 512
  s_add_u32 s57, s57, 786432
  s_mov_b32 s60, 0xffffffff
  s_mov_b32 s61, 0
  s_mov_b64 exec, s[60:61]
  buffer_store_dwordx4 v[44:47], v8, s[36:39], s57 offen sc1
  s_mov_b64 exec, -1
L_H1_EXIT:
  s_endpgm
L_FIN:
  s_cmp_ge_u32 s2, 80
  s_cbranch_scc1 L_END
  s_mov_b32 s40, s4
  s_mov_b32 s41, s5
  s_mov_b32 s42, 1280
  s_mov_b32 s43, 0x20000
  s_mov_b32 s44, s22
  s_mov_b32 s45, s23
  s_mov_b32 s46, 1280
  s_mov_b32 s47, 0x20000
  s_mov_b32 s48, s24
  s_mov_b32 s49, s25
  s_mov_b32 s50, 1280
  s_mov_b32 s51, 0x20000
  s_lshl_b32 s57, s2, 4
  v_and_b32 v6, 1, v0
  v_lshlrev_b32 v2, 3, v6
  buffer_load_dwordx2 v[10:11], v2, s[40:43], s57 offen
  buffer_load_dwordx2 v[12:13], v2, s[44:47], s57 offen
  v_lshrrev_b32 v7, 1, v0
  s_lshr_b32 s58, s2, 4
  s_and_b32 s59, s2, 15
  s_mul_i32 s58, s58, 512
  s_lshl_b32 s59, s59, 5
  s_add_u32 s58, s58, s59
  s_add_u32 s58, s58, 786432
  v_mul_u32_u24 v3, 2560, v7
  v_lshl_add_u32 v3, v6, 4, v3
  s_cmp_ge_u32 s2, 40
  s_cselect_b32 s60, 1, 0
  s_mul_i32 s61, s60, 40
  s_sub_u32 s61, s2, s61
  s_lshl_b32 s61, s61, 5
  s_mul_i32 s60, s60, 1280
  s_add_u32 s60, s60, s61
  s_add_u32 s60, s60, 458752
  s_add_u32 s61, s60, 81920
  s_add_u32 s62, s60, 163840
  s_add_u32 s63, s60, 245760
  v_mul_u32_u24 v9, 2560, v7
  v_lshl_add_u32 v9, v6, 4, v9
  s_lshl_b32 s60, s2, 12
  s_add_u32 s60, s60, 458752
  s_add_u32 s61, s60, 1024
  s_add_u32 s62, s60, 2048
  s_add_u32 s63, s60, 3072
  v_lshlrev_b32 v9, 4, v0
  s_barrier
  s_waitcnt lgkmcnt(0)
  s_add_u32 s30, s30, 1540483477
  s_add_u32 s31, s31, 625341585
  s_and_b32 s72, s30, 0xff
  s_bfe_u32 s73, s30, 0x80008
  s_bfe_u32 s74, s30, 0x80010
  s_lshr_b32 s75, s30, 24
  s_mov_b32 s56, 0
  v_mov_b32 v36, 0
  v_mov_b32 v37, 0
  v_mov_b32 v38, 0
  v_mov_b32 v39, 0
  s_mov_b32 s64, -1
  s_mov_b32 s65, 0x003fffff
  s_mov_b32 s82, 0
L_FIN_CW:
  v_mov_b32 v4, 0
  ds_read_b32 v4, v4 offset:7952
  s_waitcnt lgkmcnt(0)
  v_readfirstlane_b32 s81, v4
  s_cmp_ge_u32 s81, 4
  s_cbranch_scc1 L_FIN_CW_OK
  s_add_u32 s82, s82, 1
  s_cmp_lt_u32 s82, 3200000
  s_cbranch_scc1 L_FIN_CW
L_FIN_CW_OK:
  s_mov_b64 exec, s[64:65]
L_FIN_POLLB:
  buffer_load_dwordx4 v[36:39], v3, s[36:39], s58 offen sc1
  s_waitcnt vmcnt(0)
  v_xor_b32 v36, s72, v36
  v_xor_b32 v37, s73, v37
  v_xor_b32 v38, s74, v38
  v_xor_b32 v39, s75, v39
  v_or3_b32 v40, v36, v37, v38
  v_or_b32 v40, v40, v39
  v_and_b32 v40, 0xff, v40
  v_cmp_ne_u32 vcc, 0, v40
  s_cbranch_vccz L_FIN_POLLB_OK
  s_add_u32 s80, s80, 1
  s_cmp_lt_u32 s80, 200000
  s_cbranch_scc1 L_FIN_POLLB
L_FIN_POLLB_OK:
  s_mov_b64 exec, -1
  v_add_f32_dpp v36, v36, v36 row_ror:2 row_mask:0xf bank_mask:0xf
  v_add_f32_dpp v37, v37, v37 row_ror:2 row_mask:0xf bank_mask:0xf
  v_add_f32_dpp v38, v38, v38 row_ror:2 row_mask:0xf bank_mask:0xf
  v_add_f32_dpp v39, v39, v39 row_ror:2 row_mask:0xf bank_mask:0xf
  v_add_f32_dpp v36, v36, v36 row_ror:4 row_mask:0xf bank_mask:0xf
  v_add_f32_dpp v37, v37, v37 row_ror:4 row_mask:0xf bank_mask:0xf
  v_add_f32_dpp v38, v38, v38 row_ror:4 row_mask:0xf bank_mask:0xf
  v_add_f32_dpp v39, v39, v39 row_ror:4 row_mask:0xf bank_mask:0xf
  v_add_f32_dpp v36, v36, v36 row_ror:8 row_mask:0xf bank_mask:0xf
  v_add_f32_dpp v37, v37, v37 row_ror:8 row_mask:0xf bank_mask:0xf
  v_add_f32_dpp v38, v38, v38 row_ror:8 row_mask:0xf bank_mask:0xf
  v_add_f32_dpp v39, v39, v39 row_ror:8 row_mask:0xf bank_mask:0xf
  v_mov_b32 v40, v36
  v_mov_b32 v41, v37
  v_mov_b32 v42, v38
  v_mov_b32 v43, v39
  v_permlane16_swap_b32 v36, v40
  v_permlane16_swap_b32 v37, v41
  v_permlane16_swap_b32 v38, v42
  v_permlane16_swap_b32 v39, v43
  v_add_f32 v36, v36, v40
  v_add_f32 v37, v37, v41
  v_add_f32 v38, v38, v42
  v_add_f32 v39, v39, v43
  v_mov_b32 v40, v36
  v_mov_b32 v41, v37
  v_mov_b32 v42, v38
  v_mov_b32 v43, v39
  v_permlane32_swap_b32 v36, v40
  v_permlane32_swap_b32 v37, v41
  v_permlane32_swap_b32 v38, v42
  v_permlane32_swap_b32 v39, v43
  v_add_f32 v36, v36, v40
  v_add_f32 v37, v37, v41
  v_add_f32 v38, v38, v42
  v_add_f32 v39, v39, v43
  v_cvt_pk_bf16_f32 v36, v36, v36
  v_and_b32 v36, 0xffff0000, v36
  v_lshlrev_b32 v40, 16, v12
  v_add_f32 v36, v36, v40
  v_cvt_pk_bf16_f32 v14, v36, v36
  v_and_b32 v14, 0xffff0000, v14
  v_cvt_pk_bf16_f32 v37, v37, v37
  v_and_b32 v37, 0xffff0000, v37
  v_and_b32 v40, 0xffff0000, v12
  v_add_f32 v37, v37, v40
  v_cvt_pk_bf16_f32 v15, v37, v37
  v_and_b32 v15, 0xffff0000, v15
  v_cvt_pk_bf16_f32 v38, v38, v38
  v_and_b32 v38, 0xffff0000, v38
  v_lshlrev_b32 v40, 16, v13
  v_add_f32 v38, v38, v40
  v_cvt_pk_bf16_f32 v16, v38, v38
  v_and_b32 v16, 0xffff0000, v16
  v_cvt_pk_bf16_f32 v39, v39, v39
  v_and_b32 v39, 0xffff0000, v39
  v_and_b32 v40, 0xffff0000, v13
  v_add_f32 v39, v39, v40
  v_cvt_pk_bf16_f32 v17, v39, v39
  v_and_b32 v17, 0xffff0000, v17
  v_lshlrev_b32 v36, 16, v10
  v_and_b32 v37, 0xffff0000, v10
  v_lshlrev_b32 v38, 16, v11
  v_and_b32 v39, 0xffff0000, v11
  s_mov_b32 s82, 0
L_FIN_TW:
  v_mov_b32 v4, 0
  ds_read_b32 v4, v4 offset:7968
  s_waitcnt lgkmcnt(0)
  v_readfirstlane_b32 s81, v4
  s_cmp_lg_u32 s81, 0
  s_cbranch_scc1 L_FIN_TW_OK
  s_add_u32 s82, s82, 1
  s_cmp_lt_u32 s82, 3200000
  s_cbranch_scc1 L_FIN_TW
L_FIN_TW_OK:
L_FIN_POLLA:
  buffer_load_dwordx4 v[20:23], v9, s[36:39], s60 offen sc1
  buffer_load_dwordx4 v[24:27], v9, s[36:39], s61 offen sc1
  buffer_load_dwordx4 v[28:31], v9, s[36:39], s62 offen sc1
  buffer_load_dwordx4 v[32:35], v9, s[36:39], s63 offen sc1
L_FIN_CHK:
  s_waitcnt vmcnt(3)
  v_xor_b32 v20, s72, v20
  v_xor_b32 v21, s73, v21
  v_xor_b32 v22, s74, v22
  v_xor_b32 v23, s75, v23
  v_or3_b32 v40, v20, v21, v22
  v_or_b32 v40, v40, v23
  s_waitcnt vmcnt(2)
  v_xor_b32 v24, s72, v24
  v_xor_b32 v25, s73, v25
  v_xor_b32 v26, s74, v26
  v_xor_b32 v27, s75, v27
  v_or3_b32 v40, v40, v24, v25
  v_or3_b32 v40, v40, v26, v27
  s_waitcnt vmcnt(1)
  v_xor_b32 v28, s72, v28
  v_xor_b32 v29, s73, v29
  v_xor_b32 v30, s74, v30
  v_xor_b32 v31, s75, v31
  v_or3_b32 v40, v40, v28, v29
  v_or3_b32 v40, v40, v30, v31
  s_waitcnt vmcnt(0)
  v_xor_b32 v32, s72, v32
  v_xor_b32 v33, s73, v33
  v_xor_b32 v34, s74, v34
  v_xor_b32 v35, s75, v35
  v_or3_b32 v40, v40, v32, v33
  v_or3_b32 v40, v40, v34, v35
  v_and_b32 v40, 0xff, v40
  v_cmp_ne_u32 vcc, 0, v40
  s_cbranch_vccz L_FIN_POLLA_OK
  s_add_u32 s80, s80, 1
  s_cmp_lt_u32 s80, 200000
  s_cbranch_scc1 L_FIN_POLLA
L_FIN_POLLA_OK:
  v_add_f32 v20, v20, v24
  v_add_f32 v28, v28, v32
  v_add_f32 v21, v21, v25
  v_add_f32 v29, v29, v33
  v_add_f32 v22, v22, v26
  v_add_f32 v30, v30, v34
  v_add_f32 v23, v23, v27
  v_add_f32 v31, v31, v35
  v_add_f32 v20, v20, v28
  v_add_f32 v21, v21, v29
  v_add_f32 v22, v22, v30
  v_add_f32 v23, v23, v31
  v_add_f32_dpp v20, v20, v20 row_ror:2 row_mask:0xf bank_mask:0xf
  v_add_f32_dpp v21, v21, v21 row_ror:2 row_mask:0xf bank_mask:0xf
  v_add_f32_dpp v22, v22, v22 row_ror:2 row_mask:0xf bank_mask:0xf
  v_add_f32_dpp v23, v23, v23 row_ror:2 row_mask:0xf bank_mask:0xf
  v_add_f32_dpp v20, v20, v20 row_ror:4 row_mask:0xf bank_mask:0xf
  v_add_f32_dpp v21, v21, v21 row_ror:4 row_mask:0xf bank_mask:0xf
  v_add_f32_dpp v22, v22, v22 row_ror:4 row_mask:0xf bank_mask:0xf
  v_add_f32_dpp v23, v23, v23 row_ror:4 row_mask:0xf bank_mask:0xf
  v_add_f32_dpp v20, v20, v20 row_ror:8 row_mask:0xf bank_mask:0xf
  v_add_f32_dpp v21, v21, v21 row_ror:8 row_mask:0xf bank_mask:0xf
  v_add_f32_dpp v22, v22, v22 row_ror:8 row_mask:0xf bank_mask:0xf
  v_add_f32_dpp v23, v23, v23 row_ror:8 row_mask:0xf bank_mask:0xf
  v_mov_b32 v40, v20
  v_mov_b32 v41, v21
  v_mov_b32 v42, v22
  v_mov_b32 v43, v23
  v_permlane16_swap_b32 v20, v40
  v_permlane16_swap_b32 v21, v41
  v_permlane16_swap_b32 v22, v42
  v_permlane16_swap_b32 v23, v43
  v_add_f32 v20, v20, v40
  v_add_f32 v21, v21, v41
  v_add_f32 v22, v22, v42
  v_add_f32 v23, v23, v43
  v_mov_b32 v40, v20
  v_mov_b32 v41, v21
  v_mov_b32 v42, v22
  v_mov_b32 v43, v23
  v_permlane32_swap_b32 v20, v40
  v_permlane32_swap_b32 v21, v41
  v_permlane32_swap_b32 v22, v42
  v_permlane32_swap_b32 v23, v43
  v_add_f32 v20, v20, v40
  v_add_f32 v21, v21, v41
  v_add_f32 v22, v22, v42
  v_add_f32 v23, v23, v43
  v_cvt_pk_bf16_f32 v20, v20, v20
  v_and_b32 v20, 0xffff0000, v20
  v_add_f32 v20, v20, v36
  v_cvt_pk_bf16_f32 v20, v20, v20
  v_and_b32 v20, 0xffff0000, v20
  v_add_f32 v20, v20, v14
  v_cvt_pk_bf16_f32 v21, v21, v21
  v_and_b32 v21, 0xffff0000, v21
  v_add_f32 v21, v21, v37
  v_cvt_pk_bf16_f32 v21, v21, v21
  v_and_b32 v21, 0xffff0000, v21
  v_add_f32 v21, v21, v15
  v_cvt_pk_bf16_f32 v22, v22, v22
  v_and_b32 v22, 0xffff0000, v22
  v_add_f32 v22, v22, v38
  v_cvt_pk_bf16_f32 v22, v22, v22
  v_and_b32 v22, 0xffff0000, v22
  v_add_f32 v22, v22, v16
  v_cvt_pk_bf16_f32 v23, v23, v23
  v_and_b32 v23, 0xffff0000, v23
  v_add_f32 v23, v23, v39
  v_cvt_pk_bf16_f32 v23, v23, v23
  v_and_b32 v23, 0xffff0000, v23
  v_add_f32 v23, v23, v17
  v_cvt_pk_bf16_f32 v20, v20, v21
  v_cvt_pk_bf16_f32 v21, v22, v23
  s_mov_b64 exec, 3
  buffer_store_dwordx2 v[20:21], v2, s[48:51], s57 offen
  s_cmp_lg_u32 s2, 0
  s_cbranch_scc1 L_FIN_DONE
  s_mov_b64 exec, 1
  v_mov_b32 v4, s30
  v_mov_b32 v5, s31
  v_mov_b32 v6, 0
  buffer_store_dwordx2 v[4:5], v6, s[36:39], s56 offen sc1
L_FIN_DONE:
  s_endpgm
L_H2:
  s_barrier
  s_waitcnt lgkmcnt(0)
  s_add_u32 s30, s30, 1540483477
  s_add_u32 s31, s31, 625341585
  s_and_b32 s72, s30, 0xff
  s_bfe_u32 s73, s30, 0x80008
  s_bfe_u32 s74, s30, 0x80010
  s_lshr_b32 s75, s30, 24
  s_mov_b32 s40, s12
  s_mov_b32 s41, s13
  s_mov_b32 s42, 5242880
  s_mov_b32 s43, 0x20000
  s_lshr_b32 s58, s33, 1
  s_and_b32 s59, s33, 1
  s_lshl_b32 s56, s32, 7
  s_lshl_b32 s57, s58, 5
  s_add_u32 s56, s56, s57
  s_mul_i32 s56, s56, 1280
  s_mul_i32 s57, s59, 640
  s_add_u32 s56, s56, s57
  s_add_u32 s57, s56, 2560
  v_lshrrev_b32 v6, 3, v0
  v_and_b32 v7, 7, v0
  v_mul_u32_u24 v3, 5120, v6
  v_lshl_add_u32 v3, v7, 4, v3
  v_and_b32 v8, 1, v0
  v_cmp_eq_u32 vcc, 1, v8
  v_mov_b32 v8, 0x0000ffff
  v_mov_b32 v9, 0xffff0000
  v_cndmask_b32 v8, v8, v9, vcc
  v_and_b32 v9, 7, v0
  v_lshrrev_b32 v9, 1, v9
  v_cmp_eq_u32 vcc, 0, v9
  s_nop 1
  v_cndmask_b32 v40, 0, v8, vcc
  v_cmp_eq_u32 vcc, 1, v9
  s_nop 1
  v_cndmask_b32 v41, 0, v8, vcc
  v_cmp_eq_u32 vcc, 2, v9
  s_nop 1
  v_cndmask_b32 v42, 0, v8, vcc
  v_cmp_eq_u32 vcc, 3, v9
  s_nop 1
  v_cndmask_b32 v43, 0, v8, vcc
  v_mov_b32 v15, 0xff
  v_and_b32 v2, 31, v0
  v_lshlrev_b32 v2, 4, v2
  v_mov_b32 v10, 0
  s_lshl_b32 s60, s2, 9
  s_add_u32 s60, s60, 262144
  s_lshl_b32 s61, s32, 7
  s_add_u32 s61, s61, 393216
  s_lshl_b32 s62, s33, 4
  s_add_u32 s62, s62, s61
  s_lshl_b32 s63, s32, 12
  s_lshl_b32 s64, s58, 7
  s_add_u32 s63, s63, s64
  s_add_u32 s63, s63, 262144
  v_lshlrev_b32 v11, 9, v7
  v_lshl_add_u32 v11, v6, 4, v11
  v_lshlrev_b32 v12, 4, v7
  v_lshrrev_b32 v8, 3, v5
  v_lshrrev_b32 v9, 1, v4
  v_lshl_add_u32 v8, v8, 1, v9
  v_and_b32 v9, 7, v5
  v_lshlrev_b32 v13, 5, v9
  v_and_b32 v9, 1, v4
  v_lshl_add_u32 v13, v9, 4, v13
  v_lshl_add_u32 v13, v8, 8, v13
  v_lshlrev_b32 v14, 5, v5
  v_lshl_add_u32 v14, v4, 4, v14
  s_mul_i32 s64, s2, 1280
  s_add_u32 s64, s64, 458752
  v_and_b32 v9, 7, v5
  v_lshl_add_u32 v13, v8, 3, v9
  v_lshlrev_b32 v13, 12, v13
  v_and_b32 v9, 1, v4
  v_lshl_add_u32 v13, v9, 4, v13
  v_add_u32 v14, 32, v5
  v_lshlrev_b32 v14, 12, v14
  v_lshl_add_u32 v14, v4, 4, v14
  s_mul_i32 s64, s59, 163840
  s_lshr_b32 s65, s2, 1
  s_lshl_b32 s65, s65, 5
  s_add_u32 s64, s64, s65
  s_add_u32 s64, s64, 458752
  s_mov_b32 s66, 0x00ff00ff
  s_mov_b32 s67, 0
  s_mov_b32 s82, 0
L_H2_CW:
  v_mov_b32 v2, 0
  ds_read_b32 v2, v2 offset:7952
  s_waitcnt lgkmcnt(0)
  v_readfirstlane_b32 s81, v2
  s_cmp_ge_u32 s81, 1
  s_cbranch_scc1 L_H2_CW_OK
  s_add_u32 s82, s82, 1
  s_cmp_lt_u32 s82, 3200000
  s_cbranch_scc1 L_H2_CW
L_H2_CW_OK:
  buffer_load_dwordx4 v[100:103], v3, s[40:43], s56 offen offset:0 nt
  buffer_load_dwordx4 v[104:107], v3, s[40:43], s56 offen offset:128 nt
  buffer_load_dwordx4 v[108:111], v3, s[40:43], s56 offen offset:256 nt
  buffer_load_dwordx4 v[112:115], v3, s[40:43], s56 offen offset:384 nt
  buffer_load_dwordx4 v[116:119], v3, s[40:43], s56 offen offset:512 nt
  buffer_load_dwordx4 v[120:123], v3, s[40:43], s56 offen offset:1280 nt
  buffer_load_dwordx4 v[124:127], v3, s[40:43], s56 offen offset:1408 nt
  buffer_load_dwordx4 v[128:131], v3, s[40:43], s56 offen offset:1536 nt
  buffer_load_dwordx4 v[132:135], v3, s[40:43], s56 offen offset:1664 nt
  buffer_load_dwordx4 v[136:139], v3, s[40:43], s56 offen offset:1792 nt
  buffer_load_dwordx4 v[140:143], v3, s[40:43], s57 offen offset:0 nt
  buffer_load_dwordx4 v[144:147], v3, s[40:43], s57 offen offset:128 nt
  buffer_load_dwordx4 v[148:151], v3, s[40:43], s57 offen offset:256 nt
  buffer_load_dwordx4 v[152:155], v3, s[40:43], s57 offen offset:384 nt
  buffer_load_dwordx4 v[156:159], v3, s[40:43], s57 offen offset:512 nt
  buffer_load_dwordx4 v[160:163], v3, s[40:43], s57 offen offset:1280 nt
  buffer_load_dwordx4 v[164:167], v3, s[40:43], s57 offen offset:1408 nt
  buffer_load_dwordx4 v[168:171], v3, s[40:43], s57 offen offset:1536 nt
  buffer_load_dwordx4 v[172:175], v3, s[40:43], s57 offen offset:1664 nt
  buffer_load_dwordx4 v[176:179], v3, s[40:43], s57 offen offset:1792 nt
L_H2_POLL:
  buffer_load_dwordx4 v[20:23], v12, s[36:39], s61 offen sc1
  buffer_load_dwordx4 v[16:19], v11, s[36:39], s63 offen sc1
  s_waitcnt vmcnt(0)
  v_xor_b32 v16, s72, v16
  v_xor_b32 v17, s73, v17
  v_xor_b32 v18, s74, v18
  v_xor_b32 v19, s75, v19
  v_or3_b32 v8, v16, v17, v18
  v_or_b32 v8, v8, v19
  v_and_b32 v8, 0xff, v8
  v_bitop3_b32 v8, v8, v21, s30 bitop3:0xf6
  v_bitop3_b32 v8, v8, v23, s31 bitop3:0xf6
  v_cmp_ne_u32 vcc, 0, v8
  s_cbranch_vccz L_H2_POLL_OK
  s_add_u32 s80, s80, 1
  s_cmp_lt_u32 s80, 200000
  s_cbranch_scc1 L_H2_POLL
L_H2_POLL_OK:
  v_mov_b32 v2, 0
  v_mov_b32 v10, 1
  v_mov_b32 v8, v20
  s_nop 1
  v_max_f32_dpp v8, v8, v8 quad_perm:[1,0,3,2] row_mask:0xf bank_mask:0xf
  s_nop 1
  v_max_f32_dpp v8, v8, v8 quad_perm:[2,3,0,1] row_mask:0xf bank_mask:0xf
  s_nop 1
  v_max_f32_dpp v8, v8, v8 row_half_mirror row_mask:0xf bank_mask:0xf
  v_sub_f32 v8, v20, v8
  v_mul_f32 v8, 0x3fb8aa3b, v8
  v_exp_f32 v8, v8
  s_nop 0
  v_mul_f32 v9, v8, v22
  v_mul_f32 v16, v8, v16
  v_mul_f32 v17, v8, v17
  v_mul_f32 v18, v8, v18
  v_mul_f32 v19, v8, v19
  v_add_f32_dpp v9, v9, v9 quad_perm:[1,0,3,2] row_mask:0xf bank_mask:0xf
  v_add_f32_dpp v16, v16, v16 quad_perm:[1,0,3,2] row_mask:0xf bank_mask:0xf
  v_add_f32_dpp v17, v17, v17 quad_perm:[1,0,3,2] row_mask:0xf bank_mask:0xf
  v_add_f32_dpp v18, v18, v18 quad_perm:[1,0,3,2] row_mask:0xf bank_mask:0xf
  v_add_f32_dpp v19, v19, v19 quad_perm:[1,0,3,2] row_mask:0xf bank_mask:0xf
  v_add_f32_dpp v9, v9, v9 quad_perm:[2,3,0,1] row_mask:0xf bank_mask:0xf
  v_add_f32_dpp v16, v16, v16 quad_perm:[2,3,0,1] row_mask:0xf bank_mask:0xf
  v_add_f32_dpp v17, v17, v17 quad_perm:[2,3,0,1] row_mask:0xf bank_mask:0xf
  v_add_f32_dpp v18, v18, v18 quad_perm:[2,3,0,1] row_mask:0xf bank_mask:0xf
  v_add_f32_dpp v19, v19, v19 quad_perm:[2,3,0,1] row_mask:0xf bank_mask:0xf
  v_add_f32_dpp v9, v9, v9 row_half_mirror row_mask:0xf bank_mask:0xf
  v_add_f32_dpp v16, v16, v16 row_half_mirror row_mask:0xf bank_mask:0xf
  v_add_f32_dpp v17, v17, v17 row_half_mirror row_mask:0xf bank_mask:0xf
  v_add_f32_dpp v18, v18, v18 row_half_mirror row_mask:0xf bank_mask:0xf
  v_add_f32_dpp v19, v19, v19 row_half_mirror row_mask:0xf bank_mask:0xf
  v_rcp_f32 v9, v9
  s_nop 0
  v_mul_f32 v16, v16, v9
  v_mul_f32 v17, v17, v9
  v_mul_f32 v18, v18, v9
  v_mul_f32 v19, v19, v9
  v_cvt_pk_bf16_f32 v16, v16, v16
  v_cvt_pk_bf16_f32 v17, v17, v17
  v_cvt_pk_bf16_f32 v18, v18, v18
  v_cvt_pk_bf16_f32 v19, v19, v19
  v_and_b32 v44, v16, v40
  v_and_b32 v45, v16, v41
  v_and_b32 v46, v16, v42
  v_and_b32 v47, v16, v43
  v_and_b32 v48, v17, v40
  v_and_b32 v49, v17, v41
  v_and_b32 v50, v17, v42
  v_and_b32 v51, v17, v43
  v_and_b32 v52, v18, v40
  v_and_b32 v53, v18, v41
  v_and_b32 v54, v18, v42
  v_and_b32 v55, v18, v43
  v_and_b32 v56, v19, v40
  v_and_b32 v57, v19, v41
  v_and_b32 v58, v19, v42
  v_and_b32 v59, v19, v43
  v_mfma_f32_16x16x32_bf16 v[60:63], v[44:47], v[100:103], 0
  v_mfma_f32_16x16x32_bf16 v[64:67], v[44:47], v[104:107], 0
  v_mfma_f32_16x16x32_bf16 v[68:71], v[44:47], v[108:111], 0
  v_mfma_f32_16x16x32_bf16 v[72:75], v[44:47], v[112:115], 0
  v_mfma_f32_16x16x32_bf16 v[76:79], v[44:47], v[116:119], 0
  v_mfma_f32_16x16x32_bf16 v[60:63], v[48:51], v[120:123], v[60:63]
  v_mfma_f32_16x16x32_bf16 v[64:67], v[48:51], v[124:127], v[64:67]
  v_mfma_f32_16x16x32_bf16 v[68:71], v[48:51], v[128:131], v[68:71]
  v_mfma_f32_16x16x32_bf16 v[72:75], v[48:51], v[132:135], v[72:75]
  v_mfma_f32_16x16x32_bf16 v[76:79], v[48:51], v[136:139], v[76:79]
  v_mfma_f32_16x16x32_bf16 v[60:63], v[52:55], v[140:143], v[60:63]
  v_mfma_f32_16x16x32_bf16 v[64:67], v[52:55], v[144:147], v[64:67]
  v_mfma_f32_16x16x32_bf16 v[68:71], v[52:55], v[148:151], v[68:71]
  v_mfma_f32_16x16x32_bf16 v[72:75], v[52:55], v[152:155], v[72:75]
  v_mfma_f32_16x16x32_bf16 v[76:79], v[52:55], v[156:159], v[76:79]
  v_mfma_f32_16x16x32_bf16 v[60:63], v[56:59], v[160:163], v[60:63]
  v_mfma_f32_16x16x32_bf16 v[64:67], v[56:59], v[164:167], v[64:67]
  v_mfma_f32_16x16x32_bf16 v[68:71], v[56:59], v[168:171], v[68:71]
  v_mfma_f32_16x16x32_bf16 v[72:75], v[56:59], v[172:175], v[72:75]
  v_mfma_f32_16x16x32_bf16 v[76:79], v[56:59], v[176:179], v[76:79]
  s_nop 4
  v_permlane32_swap_b32 v60, v64
  v_permlane32_swap_b32 v61, v65
  v_permlane32_swap_b32 v62, v66
  v_permlane32_swap_b32 v63, v67
  v_permlane32_swap_b32 v68, v72
  v_permlane32_swap_b32 v69, v73
  v_permlane32_swap_b32 v70, v74
  v_permlane32_swap_b32 v71, v75
  v_add_f32_dpp v60, v64, v60 row_ror:8 row_mask:0xf bank_mask:0xf
  v_add_f32_dpp v61, v65, v61 row_ror:8 row_mask:0xf bank_mask:0xf
  v_add_f32_dpp v62, v66, v62 row_ror:8 row_mask:0xf bank_mask:0xf
  v_add_f32_dpp v63, v67, v63 row_ror:8 row_mask:0xf bank_mask:0xf
  v_add_f32_dpp v68, v72, v68 row_ror:8 row_mask:0xf bank_mask:0xf
  v_add_f32_dpp v69, v73, v69 row_ror:8 row_mask:0xf bank_mask:0xf
  v_add_f32_dpp v70, v74, v70 row_ror:8 row_mask:0xf bank_mask:0xf
  v_add_f32_dpp v71, v75, v71 row_ror:8 row_mask:0xf bank_mask:0xf
  v_mov_b32_dpp v60, v68 row_ror:8 row_mask:0xf bank_mask:0xc
  v_mov_b32_dpp v61, v69 row_ror:8 row_mask:0xf bank_mask:0xc
  v_mov_b32_dpp v62, v70 row_ror:8 row_mask:0xf bank_mask:0xc
  v_mov_b32_dpp v63, v71 row_ror:8 row_mask:0xf bank_mask:0xc
  v_bfi_b32 v60, v15, s72, v60
  v_bfi_b32 v61, v15, s73, v61
  v_bfi_b32 v62, v15, s74, v62
  v_bfi_b32 v63, v15, s75, v63
  buffer_store_dwordx4 v[60:63], v13, s[36:39], s64 offen sc1
  v_mov_b32 v64, v76
  v_mov_b32 v65, v77
  v_mov_b32 v66, v78
  v_mov_b32 v67, v79
  v_permlane32_swap_b32 v76, v64
  v_permlane32_swap_b32 v77, v65
  v_permlane32_swap_b32 v78, v66
  v_permlane32_swap_b32 v79, v67
  v_add_f32_dpp v76, v64, v76 row_ror:8 row_mask:0xf bank_mask:0xf
  v_add_f32_dpp v77, v65, v77 row_ror:8 row_mask:0xf bank_mask:0xf
  v_add_f32_dpp v78, v66, v78 row_ror:8 row_mask:0xf bank_mask:0xf
  v_add_f32_dpp v79, v67, v79 row_ror:8 row_mask:0xf bank_mask:0xf
  v_bfi_b32 v76, v15, s72, v76
  v_bfi_b32 v77, v15, s73, v77
  v_bfi_b32 v78, v15, s74, v78
  v_bfi_b32 v79, v15, s75, v79
  s_mov_b64 exec, s[66:67]
  buffer_store_dwordx4 v[76:79], v14, s[36:39], s64 offen offset:0 sc1
  ds_write_b32 v2, v10 offset:7968
  s_waitcnt lgkmcnt(0)
  s_endpgm
L_STREAM:
  s_lshl_b32 s56, s32, 22
  s_add_u32 s40, s6, s56
  s_addc_u32 s41, s7, 0
  s_mov_b32 s42, 4194304
  s_mov_b32 s43, 0x20000
  s_add_u32 s44, s8, s56
  s_addc_u32 s45, s9, 0
  s_mov_b32 s46, 4194304
  s_mov_b32 s47, 0x20000
  v_lshlrev_b32 v2, 8, v5
  v_lshl_add_u32 v2, v4, 4, v2
  v_lshlrev_b32 v3, 4, v0
  s_mul_i32 s72, s33, 524288
  s_sub_u32 s57, s3, 4
  s_lshl_b32 s57, s57, 12
  s_add_u32 s56, s72, s57
  s_lshl_b32 s57, s32, 3
  s_or_b32 s57, s57, s33
  s_mov_b32 s69, 0
  s_and_b32 s59, s57, 1
  s_bcnt1_i32_b32 s59, s59
  s_and_b32 s59, s59, 1
  s_lshl_b32 s59, s59, 6
  s_xor_b32 s69, s69, s59
  s_lshl_b32 s57, s69, 12
  s_add_u32 s56, s56, s57
  s_sub_u32 s57, s3, 4
  s_bfe_u32 s56, s57, 0x10000
  s_lshl_b32 s56, s56, 1
  s_bfe_u32 s59, s57, 0x20001
  s_lshl_b32 s59, s59, 3
  s_or_b32 s56, s56, s59
  s_bfe_u32 s59, s57, 0x10003
  s_lshl_b32 s59, s59, 2
  s_or_b32 s56, s56, s59
  s_bfe_u32 s59, s57, 0x10004
  s_or_b32 s56, s56, s59
  s_bfe_u32 s59, s57, 0x20005
  s_lshl_b32 s59, s59, 5
  s_or_b32 s56, s56, s59
  s_xor_b32 s56, s56, s69
  s_barrier
  s_xor_b32 s60, s56, 0
  s_lshl_b32 s60, s60, 12
  s_add_u32 s60, s60, s72
  buffer_load_dwordx4 v[64:67], v2, s[40:43], s60 offen offset:0 nt
  buffer_load_dwordx4 v[68:71], v2, s[40:43], s60 offen offset:64 nt
  buffer_load_dwordx4 v[72:75], v2, s[40:43], s60 offen offset:128 nt
  buffer_load_dwordx4 v[76:79], v2, s[40:43], s60 offen offset:192 nt
  buffer_load_dwordx4 v[80:83], v3, s[44:47], s60 offen offset:0 nt
  buffer_load_dwordx4 v[84:87], v3, s[44:47], s60 offen offset:1024 nt
  buffer_load_dwordx4 v[88:91], v3, s[44:47], s60 offen offset:2048 nt
  buffer_load_dwordx4 v[92:95], v3, s[44:47], s60 offen offset:3072 nt
  v_mov_b32 v57, 0
  v_mov_b32 v58, 1
  v_and_b32 v45, 1, v0
  v_cmp_eq_u32 vcc, 1, v45
  v_mov_b32 v45, 0x0000ffff
  v_mov_b32 v51, 0xffff0000
  v_cndmask_b32 v45, v45, v51, vcc
  v_and_b32 v51, 15, v0
  v_lshrrev_b32 v51, 1, v51
  v_cmp_eq_u32 vcc, 0, v51
  s_nop 1
  v_cndmask_b32 v24, 0, v45, vcc
  v_cmp_eq_u32 vcc, 1, v51
  s_nop 1
  v_cndmask_b32 v25, 0, v45, vcc
  v_cmp_eq_u32 vcc, 2, v51
  s_nop 1
  v_cndmask_b32 v26, 0, v45, vcc
  v_cmp_eq_u32 vcc, 3, v51
  s_nop 1
  v_cndmask_b32 v27, 0, v45, vcc
  v_mov_b32 v50, 0xff800000
  v_mov_b32 v49, 0
  v_mov_b32 v32, 0
  v_mov_b32 v33, 0
  v_mov_b32 v34, 0
  v_mov_b32 v35, 0
  v_lshlrev_b32 v6, 4, v4
  s_mov_b32 s81, 0
  s_cmp_lg_u32 s81, 0
  s_cbranch_scc1 L_FILL_1
  s_waitcnt vmcnt(0)
  v_mov_b32 v45, 0
  ds_read_b32 v45, v45 offset:7936
  s_waitcnt lgkmcnt(0)
  v_readfirstlane_b32 s81, v45
L_FILL_1:
  s_xor_b32 s61, s56, 16
  s_lshl_b32 s61, s61, 12
  s_add_u32 s61, s61, s72
  buffer_load_dwordx4 v[96:99], v2, s[40:43], s61 offen offset:0 nt
  buffer_load_dwordx4 v[100:103], v2, s[40:43], s61 offen offset:64 nt
  buffer_load_dwordx4 v[104:107], v2, s[40:43], s61 offen offset:128 nt
  buffer_load_dwordx4 v[108:111], v2, s[40:43], s61 offen offset:192 nt
  buffer_load_dwordx4 v[112:115], v3, s[44:47], s61 offen offset:0 nt
  buffer_load_dwordx4 v[116:119], v3, s[44:47], s61 offen offset:1024 nt
  buffer_load_dwordx4 v[120:123], v3, s[44:47], s61 offen offset:2048 nt
  buffer_load_dwordx4 v[124:127], v3, s[44:47], s61 offen offset:3072 nt
  s_cmp_lg_u32 s81, 0
  s_cbranch_scc1 L_FILL_2
  s_waitcnt vmcnt(0)
  v_mov_b32 v45, 0
  ds_read_b32 v45, v45 offset:7936
  s_waitcnt lgkmcnt(0)
  v_readfirstlane_b32 s81, v45
L_FILL_2:
  s_xor_b32 s62, s56, 4
  s_lshl_b32 s62, s62, 12
  s_add_u32 s62, s62, s72
  buffer_load_dwordx4 v[128:131], v2, s[40:43], s62 offen offset:0 nt
  buffer_load_dwordx4 v[132:135], v2, s[40:43], s62 offen offset:64 nt
  buffer_load_dwordx4 v[136:139], v2, s[40:43], s62 offen offset:128 nt
  buffer_load_dwordx4 v[140:143], v2, s[40:43], s62 offen offset:192 nt
  buffer_load_dwordx4 v[144:147], v3, s[44:47], s62 offen offset:0 nt
  buffer_load_dwordx4 v[148:151], v3, s[44:47], s62 offen offset:1024 nt
  buffer_load_dwordx4 v[152:155], v3, s[44:47], s62 offen offset:2048 nt
  buffer_load_dwordx4 v[156:159], v3, s[44:47], s62 offen offset:3072 nt
  s_cmp_lg_u32 s81, 0
  s_cbranch_scc1 L_FILL_3
  s_waitcnt vmcnt(0)
  v_mov_b32 v45, 0
  ds_read_b32 v45, v45 offset:7936
  s_waitcnt lgkmcnt(0)
  v_readfirstlane_b32 s81, v45
L_FILL_3:
  s_xor_b32 s63, s56, 20
  s_lshl_b32 s63, s63, 12
  s_add_u32 s63, s63, s72
  buffer_load_dwordx4 v[160:163], v2, s[40:43], s63 offen offset:0 nt
  buffer_load_dwordx4 v[164:167], v2, s[40:43], s63 offen offset:64 nt
  buffer_load_dwordx4 v[168:171], v2, s[40:43], s63 offen offset:128 nt
  buffer_load_dwordx4 v[172:175], v2, s[40:43], s63 offen offset:192 nt
  buffer_load_dwordx4 v[176:179], v3, s[44:47], s63 offen offset:0 nt
  buffer_load_dwordx4 v[180:183], v3, s[44:47], s63 offen offset:1024 nt
  buffer_load_dwordx4 v[184:187], v3, s[44:47], s63 offen offset:2048 nt
  buffer_load_dwordx4 v[188:191], v3, s[44:47], s63 offen offset:3072 nt
  s_cmp_lg_u32 s81, 0
  s_cbranch_scc1 L_FILL_4
  s_waitcnt vmcnt(0)
  v_mov_b32 v45, 0
  ds_read_b32 v45, v45 offset:7936
  s_waitcnt lgkmcnt(0)
  v_readfirstlane_b32 s81, v45
L_FILL_4:
  s_xor_b32 s64, s56, 1
  s_lshl_b32 s64, s64, 12
  s_add_u32 s64, s64, s72
  buffer_load_dwordx4 v[192:195], v2, s[40:43], s64 offen offset:0 nt
  buffer_load_dwordx4 v[196:199], v2, s[40:43], s64 offen offset:64 nt
  buffer_load_dwordx4 v[200:203], v2, s[40:43], s64 offen offset:128 nt
  buffer_load_dwordx4 v[204:207], v2, s[40:43], s64 offen offset:192 nt
  buffer_load_dwordx4 v[208:211], v3, s[44:47], s64 offen offset:0 nt
  buffer_load_dwordx4 v[212:215], v3, s[44:47], s64 offen offset:1024 nt
  buffer_load_dwordx4 v[216:219], v3, s[44:47], s64 offen offset:2048 nt
  buffer_load_dwordx4 v[220:223], v3, s[44:47], s64 offen offset:3072 nt
  s_cmp_lg_u32 s81, 0
  s_cbranch_scc1 L_FILL_5
  s_waitcnt vmcnt(0)
  v_mov_b32 v45, 0
  ds_read_b32 v45, v45 offset:7936
  s_waitcnt lgkmcnt(0)
  v_readfirstlane_b32 s81, v45
L_FILL_5:
  s_xor_b32 s65, s56, 17
  s_lshl_b32 s65, s65, 12
  s_add_u32 s65, s65, s72
  buffer_load_dwordx4 v[224:227], v2, s[40:43], s65 offen offset:0 nt
  buffer_load_dwordx4 v[228:231], v2, s[40:43], s65 offen offset:64 nt
  buffer_load_dwordx4 v[232:235], v2, s[40:43], s65 offen offset:128 nt
  buffer_load_dwordx4 v[236:239], v2, s[40:43], s65 offen offset:192 nt
  buffer_load_dwordx4 v[240:243], v3, s[44:47], s65 offen offset:0 nt
  buffer_load_dwordx4 v[244:247], v3, s[44:47], s65 offen offset:1024 nt
  buffer_load_dwordx4 v[248:251], v3, s[44:47], s65 offen offset:2048 nt
  buffer_load_dwordx4 v[252:255], v3, s[44:47], s65 offen offset:3072 nt
  s_mov_b32 s82, 0
L_S_QW:
  v_mov_b32 v45, 0
  ds_read_b32 v45, v45 offset:7936
  s_waitcnt lgkmcnt(0)
  v_readfirstlane_b32 s81, v45
  s_cmp_lg_u32 s81, 0
  s_cbranch_scc1 L_S_QW_OK
  s_add_u32 s82, s82, 1
  s_cmp_lt_u32 s82, 3200000
  s_cbranch_scc1 L_S_QW
L_S_QW_OK:
  ds_read_b128 v[8:11], v6 offset:5120
  ds_read_b128 v[12:15], v6 offset:5184
  ds_read_b128 v[16:19], v6 offset:5248
  ds_read_b128 v[20:23], v6 offset:5312
  s_waitcnt lgkmcnt(0)
  s_mov_b64 exec, 1
  ds_add_rtn_u32 v56, v57, v58 offset:7944
  s_mov_b64 exec, -1
  s_cmp_ge_u32 s60, 1073741824
  s_cbranch_scc1 L_SDONE
  s_waitcnt vmcnt(40)
  v_mfma_f32_16x16x32_bf16 v[28:31], v[8:11], v[64:67], 0
  v_mfma_f32_16x16x32_bf16 v[28:31], v[12:15], v[68:71], v[28:31]
  v_mfma_f32_16x16x32_bf16 v[28:31], v[16:19], v[72:75], v[28:31]
  v_mfma_f32_16x16x32_bf16 v[28:31], v[20:23], v[76:79], v[28:31]
  s_nop 7
  v_cvt_pk_bf16_f32 v45, v28, v28
  v_and_b32 v45, 0xffff0000, v45
  v_mul_f32 v45, 0x3db504f3, v45
  v_cvt_pk_bf16_f32 v44, v45, v45
  v_and_b32 v44, 0xffff0000, v44
  v_cmp_gt_f32 vcc, v44, v50
  s_cbranch_vccz L_NORESC_1
  v_max_f32_dpp v45, v44, v44 row_ror:8 row_mask:0xf bank_mask:0xf
  s_nop 1
  v_max_f32_dpp v45, v45, v45 row_ror:4 row_mask:0xf bank_mask:0xf
  s_nop 1
  v_max_f32_dpp v45, v45, v45 row_ror:2 row_mask:0xf bank_mask:0xf
  s_nop 1
  v_max_f32_dpp v45, v45, v45 row_ror:1 row_mask:0xf bank_mask:0xf
  v_max_f32 v45, v45, v50
  v_sub_f32 v51, v50, v45
  v_mul_f32 v51, 0x3fb8aa3b, v51
  v_exp_f32 v51, v51
  v_mov_b32 v50, v45
  v_mul_f32 v49, v49, v51
  v_mul_f32 v32, v32, v51
  v_mul_f32 v33, v33, v51
  v_mul_f32 v34, v34, v51
  v_mul_f32 v35, v35, v51
L_NORESC_1:
  v_sub_f32 v45, v44, v50
  v_mul_f32 v45, 0x3fb8aa3b, v45
  v_exp_f32 v46, v45
  s_nop 0
  v_cvt_pk_bf16_f32 v47, v46, v46
  v_cvt_pk_bf16_f32 v48, v46, v46
  v_add_f32 v49, v49, v46
  v_mov_b32_dpp v48, v47 row_shl:1 row_mask:0x2 bank_mask:0xf
  v_mov_b32_dpp v48, v47 row_shl:2 row_mask:0x4 bank_mask:0xf
  v_mov_b32_dpp v48, v47 row_shl:3 row_mask:0x8 bank_mask:0xf
  s_nop 1
  v_and_b32_dpp v36, v48, v24 row_newbcast:0 row_mask:0xf bank_mask:0xf
  v_and_b32_dpp v37, v48, v25 row_newbcast:0 row_mask:0xf bank_mask:0xf
  v_and_b32_dpp v38, v48, v26 row_newbcast:0 row_mask:0xf bank_mask:0xf
  v_and_b32_dpp v39, v48, v27 row_newbcast:0 row_mask:0xf bank_mask:0xf
  v_and_b32_dpp v40, v48, v24 row_newbcast:4 row_mask:0xf bank_mask:0xf
  v_and_b32_dpp v41, v48, v25 row_newbcast:4 row_mask:0xf bank_mask:0xf
  v_and_b32_dpp v42, v48, v26 row_newbcast:4 row_mask:0xf bank_mask:0xf
  v_and_b32_dpp v43, v48, v27 row_newbcast:4 row_mask:0xf bank_mask:0xf
  v_mfma_f32_16x16x32_bf16 v[32:35], v[36:39], v[80:83], v[32:35]
  v_and_b32_dpp v36, v48, v24 row_newbcast:8 row_mask:0xf bank_mask:0xf
  v_and_b32_dpp v37, v48, v25 row_newbcast:8 row_mask:0xf bank_mask:0xf
  v_and_b32_dpp v38, v48, v26 row_newbcast:8 row_mask:0xf bank_mask:0xf
  v_and_b32_dpp v39, v48, v27 row_newbcast:8 row_mask:0xf bank_mask:0xf
  v_mfma_f32_16x16x32_bf16 v[32:35], v[40:43], v[84:87], v[32:35]
  v_and_b32_dpp v40, v48, v24 row_newbcast:12 row_mask:0xf bank_mask:0xf
  v_and_b32_dpp v41, v48, v25 row_newbcast:12 row_mask:0xf bank_mask:0xf
  v_and_b32_dpp v42, v48, v26 row_newbcast:12 row_mask:0xf bank_mask:0xf
  v_and_b32_dpp v43, v48, v27 row_newbcast:12 row_mask:0xf bank_mask:0xf
  v_mfma_f32_16x16x32_bf16 v[32:35], v[36:39], v[88:91], v[32:35]
  s_nop 0
  v_mfma_f32_16x16x32_bf16 v[32:35], v[40:43], v[92:95], v[32:35]
  s_cmp_ge_u32 s61, 1073741824
  s_cbranch_scc1 L_SDONE
  s_waitcnt vmcnt(32)
  v_mfma_f32_16x16x32_bf16 v[28:31], v[8:11], v[96:99], 0
  v_mfma_f32_16x16x32_bf16 v[28:31], v[12:15], v[100:103], v[28:31]
  v_mfma_f32_16x16x32_bf16 v[28:31], v[16:19], v[104:107], v[28:31]
  v_mfma_f32_16x16x32_bf16 v[28:31], v[20:23], v[108:111], v[28:31]
  s_nop 7
  v_cvt_pk_bf16_f32 v45, v28, v28
  v_and_b32 v45, 0xffff0000, v45
  v_mul_f32 v45, 0x3db504f3, v45
  v_cvt_pk_bf16_f32 v44, v45, v45
  v_and_b32 v44, 0xffff0000, v44
  v_cmp_gt_f32 vcc, v44, v50
  s_cbranch_vccz L_NORESC_2
  v_max_f32_dpp v45, v44, v44 row_ror:8 row_mask:0xf bank_mask:0xf
  s_nop 1
  v_max_f32_dpp v45, v45, v45 row_ror:4 row_mask:0xf bank_mask:0xf
  s_nop 1
  v_max_f32_dpp v45, v45, v45 row_ror:2 row_mask:0xf bank_mask:0xf
  s_nop 1
  v_max_f32_dpp v45, v45, v45 row_ror:1 row_mask:0xf bank_mask:0xf
  v_max_f32 v45, v45, v50
  v_sub_f32 v51, v50, v45
  v_mul_f32 v51, 0x3fb8aa3b, v51
  v_exp_f32 v51, v51
  v_mov_b32 v50, v45
  v_mul_f32 v49, v49, v51
  v_mul_f32 v32, v32, v51
  v_mul_f32 v33, v33, v51
  v_mul_f32 v34, v34, v51
  v_mul_f32 v35, v35, v51
L_NORESC_2:
  v_sub_f32 v45, v44, v50
  v_mul_f32 v45, 0x3fb8aa3b, v45
  v_exp_f32 v46, v45
  s_nop 0
  v_cvt_pk_bf16_f32 v47, v46, v46
  v_cvt_pk_bf16_f32 v48, v46, v46
  v_add_f32 v49, v49, v46
  v_mov_b32_dpp v48, v47 row_shl:1 row_mask:0x2 bank_mask:0xf
  v_mov_b32_dpp v48, v47 row_shl:2 row_mask:0x4 bank_mask:0xf
  v_mov_b32_dpp v48, v47 row_shl:3 row_mask:0x8 bank_mask:0xf
  s_nop 1
  v_and_b32_dpp v36, v48, v24 row_newbcast:0 row_mask:0xf bank_mask:0xf
  v_and_b32_dpp v37, v48, v25 row_newbcast:0 row_mask:0xf bank_mask:0xf
  v_and_b32_dpp v38, v48, v26 row_newbcast:0 row_mask:0xf bank_mask:0xf
  v_and_b32_dpp v39, v48, v27 row_newbcast:0 row_mask:0xf bank_mask:0xf
  v_and_b32_dpp v40, v48, v24 row_newbcast:4 row_mask:0xf bank_mask:0xf
  v_and_b32_dpp v41, v48, v25 row_newbcast:4 row_mask:0xf bank_mask:0xf
  v_and_b32_dpp v42, v48, v26 row_newbcast:4 row_mask:0xf bank_mask:0xf
  v_and_b32_dpp v43, v48, v27 row_newbcast:4 row_mask:0xf bank_mask:0xf
  v_mfma_f32_16x16x32_bf16 v[32:35], v[36:39], v[112:115], v[32:35]
  v_and_b32_dpp v36, v48, v24 row_newbcast:8 row_mask:0xf bank_mask:0xf
  v_and_b32_dpp v37, v48, v25 row_newbcast:8 row_mask:0xf bank_mask:0xf
  v_and_b32_dpp v38, v48, v26 row_newbcast:8 row_mask:0xf bank_mask:0xf
  v_and_b32_dpp v39, v48, v27 row_newbcast:8 row_mask:0xf bank_mask:0xf
  v_mfma_f32_16x16x32_bf16 v[32:35], v[40:43], v[116:119], v[32:35]
  v_and_b32_dpp v40, v48, v24 row_newbcast:12 row_mask:0xf bank_mask:0xf
  v_and_b32_dpp v41, v48, v25 row_newbcast:12 row_mask:0xf bank_mask:0xf
  v_and_b32_dpp v42, v48, v26 row_newbcast:12 row_mask:0xf bank_mask:0xf
  v_and_b32_dpp v43, v48, v27 row_newbcast:12 row_mask:0xf bank_mask:0xf
  v_mfma_f32_16x16x32_bf16 v[32:35], v[36:39], v[120:123], v[32:35]
  s_nop 0
  v_mfma_f32_16x16x32_bf16 v[32:35], v[40:43], v[124:127], v[32:35]
  s_cmp_ge_u32 s62, 1073741824
  s_cbranch_scc1 L_SDONE
  s_waitcnt vmcnt(24)
  v_mfma_f32_16x16x32_bf16 v[28:31], v[8:11], v[128:131], 0
  v_mfma_f32_16x16x32_bf16 v[28:31], v[12:15], v[132:135], v[28:31]
  v_mfma_f32_16x16x32_bf16 v[28:31], v[16:19], v[136:139], v[28:31]
  v_mfma_f32_16x16x32_bf16 v[28:31], v[20:23], v[140:143], v[28:31]
  s_nop 7
  v_cvt_pk_bf16_f32 v45, v28, v28
  v_and_b32 v45, 0xffff0000, v45
  v_mul_f32 v45, 0x3db504f3, v45
  v_cvt_pk_bf16_f32 v44, v45, v45
  v_and_b32 v44, 0xffff0000, v44
  v_cmp_gt_f32 vcc, v44, v50
  s_cbranch_vccz L_NORESC_3
  v_max_f32_dpp v45, v44, v44 row_ror:8 row_mask:0xf bank_mask:0xf
  s_nop 1
  v_max_f32_dpp v45, v45, v45 row_ror:4 row_mask:0xf bank_mask:0xf
  s_nop 1
  v_max_f32_dpp v45, v45, v45 row_ror:2 row_mask:0xf bank_mask:0xf
  s_nop 1
  v_max_f32_dpp v45, v45, v45 row_ror:1 row_mask:0xf bank_mask:0xf
  v_max_f32 v45, v45, v50
  v_sub_f32 v51, v50, v45
  v_mul_f32 v51, 0x3fb8aa3b, v51
  v_exp_f32 v51, v51
  v_mov_b32 v50, v45
  v_mul_f32 v49, v49, v51
  v_mul_f32 v32, v32, v51
  v_mul_f32 v33, v33, v51
  v_mul_f32 v34, v34, v51
  v_mul_f32 v35, v35, v51
L_NORESC_3:
  v_sub_f32 v45, v44, v50
  v_mul_f32 v45, 0x3fb8aa3b, v45
  v_exp_f32 v46, v45
  s_nop 0
  v_cvt_pk_bf16_f32 v47, v46, v46
  v_cvt_pk_bf16_f32 v48, v46, v46
  v_add_f32 v49, v49, v46
  v_mov_b32_dpp v48, v47 row_shl:1 row_mask:0x2 bank_mask:0xf
  v_mov_b32_dpp v48, v47 row_shl:2 row_mask:0x4 bank_mask:0xf
  v_mov_b32_dpp v48, v47 row_shl:3 row_mask:0x8 bank_mask:0xf
  s_nop 1
  v_and_b32_dpp v36, v48, v24 row_newbcast:0 row_mask:0xf bank_mask:0xf
  v_and_b32_dpp v37, v48, v25 row_newbcast:0 row_mask:0xf bank_mask:0xf
  v_and_b32_dpp v38, v48, v26 row_newbcast:0 row_mask:0xf bank_mask:0xf
  v_and_b32_dpp v39, v48, v27 row_newbcast:0 row_mask:0xf bank_mask:0xf
  v_and_b32_dpp v40, v48, v24 row_newbcast:4 row_mask:0xf bank_mask:0xf
  v_and_b32_dpp v41, v48, v25 row_newbcast:4 row_mask:0xf bank_mask:0xf
  v_and_b32_dpp v42, v48, v26 row_newbcast:4 row_mask:0xf bank_mask:0xf
  v_and_b32_dpp v43, v48, v27 row_newbcast:4 row_mask:0xf bank_mask:0xf
  v_mfma_f32_16x16x32_bf16 v[32:35], v[36:39], v[144:147], v[32:35]
  v_and_b32_dpp v36, v48, v24 row_newbcast:8 row_mask:0xf bank_mask:0xf
  v_and_b32_dpp v37, v48, v25 row_newbcast:8 row_mask:0xf bank_mask:0xf
  v_and_b32_dpp v38, v48, v26 row_newbcast:8 row_mask:0xf bank_mask:0xf
  v_and_b32_dpp v39, v48, v27 row_newbcast:8 row_mask:0xf bank_mask:0xf
  v_mfma_f32_16x16x32_bf16 v[32:35], v[40:43], v[148:151], v[32:35]
  v_and_b32_dpp v40, v48, v24 row_newbcast:12 row_mask:0xf bank_mask:0xf
  v_and_b32_dpp v41, v48, v25 row_newbcast:12 row_mask:0xf bank_mask:0xf
  v_and_b32_dpp v42, v48, v26 row_newbcast:12 row_mask:0xf bank_mask:0xf
  v_and_b32_dpp v43, v48, v27 row_newbcast:12 row_mask:0xf bank_mask:0xf
  v_mfma_f32_16x16x32_bf16 v[32:35], v[36:39], v[152:155], v[32:35]
  s_nop 0
  v_mfma_f32_16x16x32_bf16 v[32:35], v[40:43], v[156:159], v[32:35]
  s_cmp_ge_u32 s63, 1073741824
  s_cbranch_scc1 L_SDONE
  s_waitcnt vmcnt(16)
  v_mfma_f32_16x16x32_bf16 v[28:31], v[8:11], v[160:163], 0
  v_mfma_f32_16x16x32_bf16 v[28:31], v[12:15], v[164:167], v[28:31]
  v_mfma_f32_16x16x32_bf16 v[28:31], v[16:19], v[168:171], v[28:31]
  v_mfma_f32_16x16x32_bf16 v[28:31], v[20:23], v[172:175], v[28:31]
  s_nop 7
  v_cvt_pk_bf16_f32 v45, v28, v28
  v_and_b32 v45, 0xffff0000, v45
  v_mul_f32 v45, 0x3db504f3, v45
  v_cvt_pk_bf16_f32 v44, v45, v45
  v_and_b32 v44, 0xffff0000, v44
  v_cmp_gt_f32 vcc, v44, v50
  s_cbranch_vccz L_NORESC_4
  v_max_f32_dpp v45, v44, v44 row_ror:8 row_mask:0xf bank_mask:0xf
  s_nop 1
  v_max_f32_dpp v45, v45, v45 row_ror:4 row_mask:0xf bank_mask:0xf
  s_nop 1
  v_max_f32_dpp v45, v45, v45 row_ror:2 row_mask:0xf bank_mask:0xf
  s_nop 1
  v_max_f32_dpp v45, v45, v45 row_ror:1 row_mask:0xf bank_mask:0xf
  v_max_f32 v45, v45, v50
  v_sub_f32 v51, v50, v45
  v_mul_f32 v51, 0x3fb8aa3b, v51
  v_exp_f32 v51, v51
  v_mov_b32 v50, v45
  v_mul_f32 v49, v49, v51
  v_mul_f32 v32, v32, v51
  v_mul_f32 v33, v33, v51
  v_mul_f32 v34, v34, v51
  v_mul_f32 v35, v35, v51
L_NORESC_4:
  v_sub_f32 v45, v44, v50
  v_mul_f32 v45, 0x3fb8aa3b, v45
  v_exp_f32 v46, v45
  s_nop 0
  v_cvt_pk_bf16_f32 v47, v46, v46
  v_cvt_pk_bf16_f32 v48, v46, v46
  v_add_f32 v49, v49, v46
  v_mov_b32_dpp v48, v47 row_shl:1 row_mask:0x2 bank_mask:0xf
  v_mov_b32_dpp v48, v47 row_shl:2 row_mask:0x4 bank_mask:0xf
  v_mov_b32_dpp v48, v47 row_shl:3 row_mask:0x8 bank_mask:0xf
  s_nop 1
  v_and_b32_dpp v36, v48, v24 row_newbcast:0 row_mask:0xf bank_mask:0xf
  v_and_b32_dpp v37, v48, v25 row_newbcast:0 row_mask:0xf bank_mask:0xf
  v_and_b32_dpp v38, v48, v26 row_newbcast:0 row_mask:0xf bank_mask:0xf
  v_and_b32_dpp v39, v48, v27 row_newbcast:0 row_mask:0xf bank_mask:0xf
  v_and_b32_dpp v40, v48, v24 row_newbcast:4 row_mask:0xf bank_mask:0xf
  v_and_b32_dpp v41, v48, v25 row_newbcast:4 row_mask:0xf bank_mask:0xf
  v_and_b32_dpp v42, v48, v26 row_newbcast:4 row_mask:0xf bank_mask:0xf
  v_and_b32_dpp v43, v48, v27 row_newbcast:4 row_mask:0xf bank_mask:0xf
  v_mfma_f32_16x16x32_bf16 v[32:35], v[36:39], v[176:179], v[32:35]
  v_and_b32_dpp v36, v48, v24 row_newbcast:8 row_mask:0xf bank_mask:0xf
  v_and_b32_dpp v37, v48, v25 row_newbcast:8 row_mask:0xf bank_mask:0xf
  v_and_b32_dpp v38, v48, v26 row_newbcast:8 row_mask:0xf bank_mask:0xf
  v_and_b32_dpp v39, v48, v27 row_newbcast:8 row_mask:0xf bank_mask:0xf
  v_mfma_f32_16x16x32_bf16 v[32:35], v[40:43], v[180:183], v[32:35]
  v_and_b32_dpp v40, v48, v24 row_newbcast:12 row_mask:0xf bank_mask:0xf
  v_and_b32_dpp v41, v48, v25 row_newbcast:12 row_mask:0xf bank_mask:0xf
  v_and_b32_dpp v42, v48, v26 row_newbcast:12 row_mask:0xf bank_mask:0xf
  v_and_b32_dpp v43, v48, v27 row_newbcast:12 row_mask:0xf bank_mask:0xf
  v_mfma_f32_16x16x32_bf16 v[32:35], v[36:39], v[184:187], v[32:35]
  s_nop 0
  v_mfma_f32_16x16x32_bf16 v[32:35], v[40:43], v[188:191], v[32:35]
L_SLOOP:
  s_cmp_ge_u32 s64, 1073741824
  s_cbranch_scc1 L_SDONE
  s_waitcnt vmcnt(8)
  s_waitcnt lgkmcnt(0)
  v_readfirstlane_b32 s58, v56
  s_bfe_u32 s59, s58, 0x10000
  s_lshl_b32 s59, s59, 1
  s_bfe_u32 s57, s58, 0x20001
  s_lshl_b32 s57, s57, 3
  s_or_b32 s59, s59, s57
  s_bfe_u32 s57, s58, 0x10003
  s_lshl_b32 s57, s57, 2
  s_or_b32 s59, s59, s57
  s_bfe_u32 s57, s58, 0x10004
  s_or_b32 s59, s59, s57
  s_bfe_u32 s57, s58, 0x20005
  s_lshl_b32 s57, s57, 5
  s_or_b32 s59, s59, s57
  s_xor_b32 s59, s59, s69
  s_lshl_b32 s59, s59, 12
  s_add_u32 s59, s59, s72
  s_cmp_lt_u32 s58, 120
  s_cbranch_scc1 L_TK_1
  s_lshl_b32 s58, s58, 2
  v_mov_b32 v45, s58
  s_mov_b32 s82, 0
L_TB_1:
  ds_read_b32 v51, v45 offset:7712
  s_waitcnt lgkmcnt(0)
  v_readfirstlane_b32 s59, v51
  s_cmp_lg_u32 s59, -1
  s_cbranch_scc1 L_TK_1
  s_add_u32 s82, s82, 1
  s_cmp_lt_u32 s82, 3200000
  s_cbranch_scc1 L_TB_1
L_TK_1:
  s_mov_b32 s63, s59
  buffer_load_dwordx4 v[160:163], v2, s[40:43], s63 offen offset:0 nt
  buffer_load_dwordx4 v[164:167], v2, s[40:43], s63 offen offset:64 nt
  buffer_load_dwordx4 v[168:171], v2, s[40:43], s63 offen offset:128 nt
  buffer_load_dwordx4 v[172:175], v2, s[40:43], s63 offen offset:192 nt
  buffer_load_dwordx4 v[176:179], v3, s[44:47], s63 offen offset:0 nt
  buffer_load_dwordx4 v[180:183], v3, s[44:47], s63 offen offset:1024 nt
  buffer_load_dwordx4 v[184:187], v3, s[44:47], s63 offen offset:2048 nt
  buffer_load_dwordx4 v[188:191], v3, s[44:47], s63 offen offset:3072 nt
  s_mov_b64 exec, 1
  ds_add_rtn_u32 v56, v57, v58 offset:7944
  s_mov_b64 exec, -1
  v_mfma_f32_16x16x32_bf16 v[28:31], v[8:11], v[192:195], 0
  v_mfma_f32_16x16x32_bf16 v[28:31], v[12:15], v[196:199], v[28:31]
  v_mfma_f32_16x16x32_bf16 v[28:31], v[16:19], v[200:203], v[28:31]
  v_mfma_f32_16x16x32_bf16 v[28:31], v[20:23], v[204:207], v[28:31]
  s_nop 7
  v_cvt_pk_bf16_f32 v45, v28, v28
  v_and_b32 v45, 0xffff0000, v45
  v_mul_f32 v45, 0x3db504f3, v45
  v_cvt_pk_bf16_f32 v44, v45, v45
  v_and_b32 v44, 0xffff0000, v44
  v_cmp_gt_f32 vcc, v44, v50
  s_cbranch_vccz L_NORESC_5
  v_max_f32_dpp v45, v44, v44 row_ror:8 row_mask:0xf bank_mask:0xf
  s_nop 1
  v_max_f32_dpp v45, v45, v45 row_ror:4 row_mask:0xf bank_mask:0xf
  s_nop 1
  v_max_f32_dpp v45, v45, v45 row_ror:2 row_mask:0xf bank_mask:0xf
  s_nop 1
  v_max_f32_dpp v45, v45, v45 row_ror:1 row_mask:0xf bank_mask:0xf
  v_max_f32 v45, v45, v50
  v_sub_f32 v51, v50, v45
  v_mul_f32 v51, 0x3fb8aa3b, v51
  v_exp_f32 v51, v51
  v_mov_b32 v50, v45
  v_mul_f32 v49, v49, v51
  v_mul_f32 v32, v32, v51
  v_mul_f32 v33, v33, v51
  v_mul_f32 v34, v34, v51
  v_mul_f32 v35, v35, v51
L_NORESC_5:
  v_sub_f32 v45, v44, v50
  v_mul_f32 v45, 0x3fb8aa3b, v45
  v_exp_f32 v46, v45
  s_nop 0
  v_cvt_pk_bf16_f32 v47, v46, v46
  v_cvt_pk_bf16_f32 v48, v46, v46
  v_add_f32 v49, v49, v46
  v_mov_b32_dpp v48, v47 row_shl:1 row_mask:0x2 bank_mask:0xf
  v_mov_b32_dpp v48, v47 row_shl:2 row_mask:0x4 bank_mask:0xf
  v_mov_b32_dpp v48, v47 row_shl:3 row_mask:0x8 bank_mask:0xf
  s_nop 1
  v_and_b32_dpp v36, v48, v24 row_newbcast:0 row_mask:0xf bank_mask:0xf
  v_and_b32_dpp v37, v48, v25 row_newbcast:0 row_mask:0xf bank_mask:0xf
  v_and_b32_dpp v38, v48, v26 row_newbcast:0 row_mask:0xf bank_mask:0xf
  v_and_b32_dpp v39, v48, v27 row_newbcast:0 row_mask:0xf bank_mask:0xf
  v_and_b32_dpp v40, v48, v24 row_newbcast:4 row_mask:0xf bank_mask:0xf
  v_and_b32_dpp v41, v48, v25 row_newbcast:4 row_mask:0xf bank_mask:0xf
  v_and_b32_dpp v42, v48, v26 row_newbcast:4 row_mask:0xf bank_mask:0xf
  v_and_b32_dpp v43, v48, v27 row_newbcast:4 row_mask:0xf bank_mask:0xf
  v_mfma_f32_16x16x32_bf16 v[32:35], v[36:39], v[208:211], v[32:35]
  v_and_b32_dpp v36, v48, v24 row_newbcast:8 row_mask:0xf bank_mask:0xf
  v_and_b32_dpp v37, v48, v25 row_newbcast:8 row_mask:0xf bank_mask:0xf
  v_and_b32_dpp v38, v48, v26 row_newbcast:8 row_mask:0xf bank_mask:0xf
  v_and_b32_dpp v39, v48, v27 row_newbcast:8 row_mask:0xf bank_mask:0xf
  v_mfma_f32_16x16x32_bf16 v[32:35], v[40:43], v[212:215], v[32:35]
  v_and_b32_dpp v40, v48, v24 row_newbcast:12 row_mask:0xf bank_mask:0xf
  v_and_b32_dpp v41, v48, v25 row_newbcast:12 row_mask:0xf bank_mask:0xf
  v_and_b32_dpp v42, v48, v26 row_newbcast:12 row_mask:0xf bank_mask:0xf
  v_and_b32_dpp v43, v48, v27 row_newbcast:12 row_mask:0xf bank_mask:0xf
  v_mfma_f32_16x16x32_bf16 v[32:35], v[36:39], v[216:219], v[32:35]
  s_nop 0
  v_mfma_f32_16x16x32_bf16 v[32:35], v[40:43], v[220:223], v[32:35]
  s_cmp_ge_u32 s65, 1073741824
  s_cbranch_scc1 L_SDONE
  s_waitcnt vmcnt(8)
  s_waitcnt lgkmcnt(0)
  v_readfirstlane_b32 s58, v56
  s_bfe_u32 s59, s58, 0x10000
  s_lshl_b32 s59, s59, 1
  s_bfe_u32 s57, s58, 0x20001
  s_lshl_b32 s57, s57, 3
  s_or_b32 s59, s59, s57
  s_bfe_u32 s57, s58, 0x10003
  s_lshl_b32 s57, s57, 2
  s_or_b32 s59, s59, s57
  s_bfe_u32 s57, s58, 0x10004
  s_or_b32 s59, s59, s57
  s_bfe_u32 s57, s58, 0x20005
  s_lshl_b32 s57, s57, 5
  s_or_b32 s59, s59, s57
  s_xor_b32 s59, s59, s69
  s_lshl_b32 s59, s59, 12
  s_add_u32 s59, s59, s72
  s_cmp_lt_u32 s58, 120
  s_cbranch_scc1 L_TK_2
  s_lshl_b32 s58, s58, 2
  v_mov_b32 v45, s58
  s_mov_b32 s82, 0
L_TB_2:
  ds_read_b32 v51, v45 offset:7712
  s_waitcnt lgkmcnt(0)
  v_readfirstlane_b32 s59, v51
  s_cmp_lg_u32 s59, -1
  s_cbranch_scc1 L_TK_2
  s_add_u32 s82, s82, 1
  s_cmp_lt_u32 s82, 3200000
  s_cbranch_scc1 L_TB_2
L_TK_2:
  s_mov_b32 s64, s59
  buffer_load_dwordx4 v[192:195], v2, s[40:43], s64 offen offset:0 nt
  buffer_load_dwordx4 v[196:199], v2, s[40:43], s64 offen offset:64 nt
  buffer_load_dwordx4 v[200:203], v2, s[40:43], s64 offen offset:128 nt
  buffer_load_dwordx4 v[204:207], v2, s[40:43], s64 offen offset:192 nt
  buffer_load_dwordx4 v[208:211], v3, s[44:47], s64 offen offset:0 nt
  buffer_load_dwordx4 v[212:215], v3, s[44:47], s64 offen offset:1024 nt
  buffer_load_dwordx4 v[216:219], v3, s[44:47], s64 offen offset:2048 nt
  buffer_load_dwordx4 v[220:223], v3, s[44:47], s64 offen offset:3072 nt
  s_mov_b64 exec, 1
  ds_add_rtn_u32 v56, v57, v58 offset:7944
  s_mov_b64 exec, -1
  v_mfma_f32_16x16x32_bf16 v[28:31], v[8:11], v[224:227], 0
  v_mfma_f32_16x16x32_bf16 v[28:31], v[12:15], v[228:231], v[28:31]
  v_mfma_f32_16x16x32_bf16 v[28:31], v[16:19], v[232:235], v[28:31]
  v_mfma_f32_16x16x32_bf16 v[28:31], v[20:23], v[236:239], v[28:31]
  s_nop 7
  v_cvt_pk_bf16_f32 v45, v28, v28
  v_and_b32 v45, 0xffff0000, v45
  v_mul_f32 v45, 0x3db504f3, v45
  v_cvt_pk_bf16_f32 v44, v45, v45
  v_and_b32 v44, 0xffff0000, v44
  v_cmp_gt_f32 vcc, v44, v50
  s_cbranch_vccz L_NORESC_6
  v_max_f32_dpp v45, v44, v44 row_ror:8 row_mask:0xf bank_mask:0xf
  s_nop 1
  v_max_f32_dpp v45, v45, v45 row_ror:4 row_mask:0xf bank_mask:0xf
  s_nop 1
  v_max_f32_dpp v45, v45, v45 row_ror:2 row_mask:0xf bank_mask:0xf
  s_nop 1
  v_max_f32_dpp v45, v45, v45 row_ror:1 row_mask:0xf bank_mask:0xf
  v_max_f32 v45, v45, v50
  v_sub_f32 v51, v50, v45
  v_mul_f32 v51, 0x3fb8aa3b, v51
  v_exp_f32 v51, v51
  v_mov_b32 v50, v45
  v_mul_f32 v49, v49, v51
  v_mul_f32 v32, v32, v51
  v_mul_f32 v33, v33, v51
  v_mul_f32 v34, v34, v51
  v_mul_f32 v35, v35, v51
L_NORESC_6:
  v_sub_f32 v45, v44, v50
  v_mul_f32 v45, 0x3fb8aa3b, v45
  v_exp_f32 v46, v45
  s_nop 0
  v_cvt_pk_bf16_f32 v47, v46, v46
  v_cvt_pk_bf16_f32 v48, v46, v46
  v_add_f32 v49, v49, v46
  v_mov_b32_dpp v48, v47 row_shl:1 row_mask:0x2 bank_mask:0xf
  v_mov_b32_dpp v48, v47 row_shl:2 row_mask:0x4 bank_mask:0xf
  v_mov_b32_dpp v48, v47 row_shl:3 row_mask:0x8 bank_mask:0xf
  s_nop 1
  v_and_b32_dpp v36, v48, v24 row_newbcast:0 row_mask:0xf bank_mask:0xf
  v_and_b32_dpp v37, v48, v25 row_newbcast:0 row_mask:0xf bank_mask:0xf
  v_and_b32_dpp v38, v48, v26 row_newbcast:0 row_mask:0xf bank_mask:0xf
  v_and_b32_dpp v39, v48, v27 row_newbcast:0 row_mask:0xf bank_mask:0xf
  v_and_b32_dpp v40, v48, v24 row_newbcast:4 row_mask:0xf bank_mask:0xf
  v_and_b32_dpp v41, v48, v25 row_newbcast:4 row_mask:0xf bank_mask:0xf
  v_and_b32_dpp v42, v48, v26 row_newbcast:4 row_mask:0xf bank_mask:0xf
  v_and_b32_dpp v43, v48, v27 row_newbcast:4 row_mask:0xf bank_mask:0xf
  v_mfma_f32_16x16x32_bf16 v[32:35], v[36:39], v[240:243], v[32:35]
  v_and_b32_dpp v36, v48, v24 row_newbcast:8 row_mask:0xf bank_mask:0xf
  v_and_b32_dpp v37, v48, v25 row_newbcast:8 row_mask:0xf bank_mask:0xf
  v_and_b32_dpp v38, v48, v26 row_newbcast:8 row_mask:0xf bank_mask:0xf
  v_and_b32_dpp v39, v48, v27 row_newbcast:8 row_mask:0xf bank_mask:0xf
  v_mfma_f32_16x16x32_bf16 v[32:35], v[40:43], v[244:247], v[32:35]
  v_and_b32_dpp v40, v48, v24 row_newbcast:12 row_mask:0xf bank_mask:0xf
  v_and_b32_dpp v41, v48, v25 row_newbcast:12 row_mask:0xf bank_mask:0xf
  v_and_b32_dpp v42, v48, v26 row_newbcast:12 row_mask:0xf bank_mask:0xf
  v_and_b32_dpp v43, v48, v27 row_newbcast:12 row_mask:0xf bank_mask:0xf
  v_mfma_f32_16x16x32_bf16 v[32:35], v[36:39], v[248:251], v[32:35]
  s_nop 0
  v_mfma_f32_16x16x32_bf16 v[32:35], v[40:43], v[252:255], v[32:35]
  s_cmp_ge_u32 s63, 1073741824
  s_cbranch_scc1 L_SDONE
  s_waitcnt vmcnt(8)
  s_waitcnt lgkmcnt(0)
  v_readfirstlane_b32 s58, v56
  s_bfe_u32 s59, s58, 0x10000
  s_lshl_b32 s59, s59, 1
  s_bfe_u32 s57, s58, 0x20001
  s_lshl_b32 s57, s57, 3
  s_or_b32 s59, s59, s57
  s_bfe_u32 s57, s58, 0x10003
  s_lshl_b32 s57, s57, 2
  s_or_b32 s59, s59, s57
  s_bfe_u32 s57, s58, 0x10004
  s_or_b32 s59, s59, s57
  s_bfe_u32 s57, s58, 0x20005
  s_lshl_b32 s57, s57, 5
  s_or_b32 s59, s59, s57
  s_xor_b32 s59, s59, s69
  s_lshl_b32 s59, s59, 12
  s_add_u32 s59, s59, s72
  s_cmp_lt_u32 s58, 120
  s_cbranch_scc1 L_TK_3
  s_lshl_b32 s58, s58, 2
  v_mov_b32 v45, s58
  s_mov_b32 s82, 0
L_TB_3:
  ds_read_b32 v51, v45 offset:7712
  s_waitcnt lgkmcnt(0)
  v_readfirstlane_b32 s59, v51
  s_cmp_lg_u32 s59, -1
  s_cbranch_scc1 L_TK_3
  s_add_u32 s82, s82, 1
  s_cmp_lt_u32 s82, 3200000
  s_cbranch_scc1 L_TB_3
L_TK_3:
  s_mov_b32 s65, s59
  buffer_load_dwordx4 v[224:227], v2, s[40:43], s65 offen offset:0 nt
  buffer_load_dwordx4 v[228:231], v2, s[40:43], s65 offen offset:64 nt
  buffer_load_dwordx4 v[232:235], v2, s[40:43], s65 offen offset:128 nt
  buffer_load_dwordx4 v[236:239], v2, s[40:43], s65 offen offset:192 nt
  buffer_load_dwordx4 v[240:243], v3, s[44:47], s65 offen offset:0 nt
  buffer_load_dwordx4 v[244:247], v3, s[44:47], s65 offen offset:1024 nt
  buffer_load_dwordx4 v[248:251], v3, s[44:47], s65 offen offset:2048 nt
  buffer_load_dwordx4 v[252:255], v3, s[44:47], s65 offen offset:3072 nt
  s_mov_b64 exec, 1
  ds_add_rtn_u32 v56, v57, v58 offset:7944
  s_mov_b64 exec, -1
  v_mfma_f32_16x16x32_bf16 v[28:31], v[8:11], v[160:163], 0
  v_mfma_f32_16x16x32_bf16 v[28:31], v[12:15], v[164:167], v[28:31]
  v_mfma_f32_16x16x32_bf16 v[28:31], v[16:19], v[168:171], v[28:31]
  v_mfma_f32_16x16x32_bf16 v[28:31], v[20:23], v[172:175], v[28:31]
  s_nop 7
  v_cvt_pk_bf16_f32 v45, v28, v28
  v_and_b32 v45, 0xffff0000, v45
  v_mul_f32 v45, 0x3db504f3, v45
  v_cvt_pk_bf16_f32 v44, v45, v45
  v_and_b32 v44, 0xffff0000, v44
  v_cmp_gt_f32 vcc, v44, v50
  s_cbranch_vccz L_NORESC_7
  v_max_f32_dpp v45, v44, v44 row_ror:8 row_mask:0xf bank_mask:0xf
  s_nop 1
  v_max_f32_dpp v45, v45, v45 row_ror:4 row_mask:0xf bank_mask:0xf
  s_nop 1
  v_max_f32_dpp v45, v45, v45 row_ror:2 row_mask:0xf bank_mask:0xf
  s_nop 1
  v_max_f32_dpp v45, v45, v45 row_ror:1 row_mask:0xf bank_mask:0xf
  v_max_f32 v45, v45, v50
  v_sub_f32 v51, v50, v45
  v_mul_f32 v51, 0x3fb8aa3b, v51
  v_exp_f32 v51, v51
  v_mov_b32 v50, v45
  v_mul_f32 v49, v49, v51
  v_mul_f32 v32, v32, v51
  v_mul_f32 v33, v33, v51
  v_mul_f32 v34, v34, v51
  v_mul_f32 v35, v35, v51
L_NORESC_7:
  v_sub_f32 v45, v44, v50
  v_mul_f32 v45, 0x3fb8aa3b, v45
  v_exp_f32 v46, v45
  s_nop 0
  v_cvt_pk_bf16_f32 v47, v46, v46
  v_cvt_pk_bf16_f32 v48, v46, v46
  v_add_f32 v49, v49, v46
  v_mov_b32_dpp v48, v47 row_shl:1 row_mask:0x2 bank_mask:0xf
  v_mov_b32_dpp v48, v47 row_shl:2 row_mask:0x4 bank_mask:0xf
  v_mov_b32_dpp v48, v47 row_shl:3 row_mask:0x8 bank_mask:0xf
  s_nop 1
  v_and_b32_dpp v36, v48, v24 row_newbcast:0 row_mask:0xf bank_mask:0xf
  v_and_b32_dpp v37, v48, v25 row_newbcast:0 row_mask:0xf bank_mask:0xf
  v_and_b32_dpp v38, v48, v26 row_newbcast:0 row_mask:0xf bank_mask:0xf
  v_and_b32_dpp v39, v48, v27 row_newbcast:0 row_mask:0xf bank_mask:0xf
  v_and_b32_dpp v40, v48, v24 row_newbcast:4 row_mask:0xf bank_mask:0xf
  v_and_b32_dpp v41, v48, v25 row_newbcast:4 row_mask:0xf bank_mask:0xf
  v_and_b32_dpp v42, v48, v26 row_newbcast:4 row_mask:0xf bank_mask:0xf
  v_and_b32_dpp v43, v48, v27 row_newbcast:4 row_mask:0xf bank_mask:0xf
  v_mfma_f32_16x16x32_bf16 v[32:35], v[36:39], v[176:179], v[32:35]
  v_and_b32_dpp v36, v48, v24 row_newbcast:8 row_mask:0xf bank_mask:0xf
  v_and_b32_dpp v37, v48, v25 row_newbcast:8 row_mask:0xf bank_mask:0xf
  v_and_b32_dpp v38, v48, v26 row_newbcast:8 row_mask:0xf bank_mask:0xf
  v_and_b32_dpp v39, v48, v27 row_newbcast:8 row_mask:0xf bank_mask:0xf
  v_mfma_f32_16x16x32_bf16 v[32:35], v[40:43], v[180:183], v[32:35]
  v_and_b32_dpp v40, v48, v24 row_newbcast:12 row_mask:0xf bank_mask:0xf
  v_and_b32_dpp v41, v48, v25 row_newbcast:12 row_mask:0xf bank_mask:0xf
  v_and_b32_dpp v42, v48, v26 row_newbcast:12 row_mask:0xf bank_mask:0xf
  v_and_b32_dpp v43, v48, v27 row_newbcast:12 row_mask:0xf bank_mask:0xf
  v_mfma_f32_16x16x32_bf16 v[32:35], v[36:39], v[184:187], v[32:35]
  s_nop 0
  v_mfma_f32_16x16x32_bf16 v[32:35], v[40:43], v[188:191], v[32:35]
  s_branch L_SLOOP
L_SDONE:
  v_add_f32_dpp v49, v49, v49 row_ror:8 row_mask:0xf bank_mask:0xf
  s_nop 1
  v_add_f32_dpp v49, v49, v49 row_ror:4 row_mask:0xf bank_mask:0xf
  s_nop 1
  v_add_f32_dpp v49, v49, v49 row_ror:2 row_mask:0xf bank_mask:0xf
  s_nop 1
  v_add_f32_dpp v49, v49, v49 row_ror:1 row_mask:0xf bank_mask:0xf
  v_lshlrev_b32 v6, 5, v5
  v_lshl_add_u32 v6, v4, 4, v6
  s_sub_u32 s58, s3, 4
  s_mul_i32 s58, s58, 576
  v_add_u32 v6, s58, v6
  v_mov_b32 v7, s58
  v_mov_b32 v52, v50
  v_mov_b32 v53, v49
  s_mov_b32 exec_hi, 0
  ds_write_b128 v6, v[32:35] offset:5376
  s_mov_b64 exec, 1
  ds_write_b64 v7, v[52:53] offset:5888
  s_waitcnt lgkmcnt(0)
  ds_add_u32 v57, v58 offset:7952
  s_mov_b64 exec, -1
  s_waitcnt lgkmcnt(0)
L_END:
  s_endpgm
.section .rodata,"a"
.p2align 6
.amdhsa_kernel parallel_sum__gqa_block_cached__mixer_channel_mlp__decode_kernel
  .amdhsa_next_free_vgpr 256
  .amdhsa_next_free_sgpr 102
  .amdhsa_accum_offset 256
  .amdhsa_group_segment_fixed_size 0
  .amdhsa_kernarg_size 104
  .amdhsa_user_sgpr_count 2
  .amdhsa_user_sgpr_kernarg_segment_ptr 1
  .amdhsa_system_sgpr_workgroup_id_x 1
.end_amdhsa_kernel
```
